```python
import torch

def _softmax(x, axis=-1):
    return torch.softmax(x, dim=axis)

def _gelu(x):
    return torch.nn.functional.gelu(x, approximate='tanh')

def _silu(x):
    return torch.nn.functional.silu(x)

def _sigmoid(x):
    return torch.sigmoid(x)

def _layernorm(x, axis=-1, eps=1e-05):
    m = x.mean(dim=axis, keepdim=True)
    v = x.var(dim=axis, keepdim=True, unbiased=False)
    return (x - m) / torch.sqrt(v + eps)

def _scatter_add(tgt, idx, src, axis=0):
    return tgt.clone().index_add_(axis, idx, src)

def _segment_sum(src, seg, n):
    out = torch.zeros((n,) + src.shape[1:], dtype=src.dtype)
    return out.index_add_(0, seg, src)

def _pad(x, pw):
    flat = tuple((v for pair in reversed(pw) for v in pair))
    return torch.nn.functional.pad(x, flat)
kernel_name = 'gather_scatter__tensor_product_equiv_equiformer__graph'

def setup_inputs():

    _w = lambda a: (lambda t: t.to(torch.bfloat16) if t.is_floating_point() else t)(torch.as_tensor(a))
    N, deg, C, De = (50000, 16, 64, max(16, 1))
    E = N * deg
    src = (lambda lo, hi, *s: torch.randint(lo, hi, s))(0, N, E).to(torch.int64)
    dst = (lambda lo, hi, *s: torch.randint(lo, hi, s))(0, N, E).to(torch.int64)
    rvec = (lambda *s: torch.randn(*s, dtype=torch.bfloat16) * 0.05)(E, 3).to(float)
    rn = (torch.linalg.norm(rvec, dim=-1, keepdim=True) + 1e-06).to(float)
    rhat = (rvec / rn).to(float)
    eps = torch.zeros((3, 3, 3), dtype=float)
    eps[0, 1, 2] = eps[1, 2, 0] = eps[2, 0, 1] = 1.0
    eps[0, 2, 1] = eps[2, 1, 0] = eps[1, 0, 2] = -1.0
    return {'x': _w((lambda *s: torch.randn(*s, dtype=torch.bfloat16) * 0.2)(N, 4 * C).to(float)), 'rhat': _w(rhat), 'e_attr': _w((lambda *s: torch.randn(*s, dtype=torch.bfloat16) * 0.2)(E, De).to(float)), 'src': _w(src), 'dst': _w(dst), 'w_rad': _w((lambda *s: torch.randn(*s, dtype=torch.bfloat16) * 0.2)(De, 5 * C).to(float)), 'w_si0': _w((lambda *s: torch.randn(*s, dtype=torch.bfloat16) * 0.2)(2 * C, C).to(float)), 'w_si1': _w((lambda *s: torch.randn(*s, dtype=torch.bfloat16) * 0.05)(3 * C, C).to(float)), 'cg_eps': _w(eps)}

def reference(x, rhat, e_attr, src, dst, w_rad, w_si0, w_si1, cg_eps):
    N = x.shape[0]
    C = w_si0.shape[1]
    E = rhat.shape[0]
    x0 = x[:, :C].clone()
    x1 = x[:, C:].reshape(N, 3, C)
    R = (e_attr @ w_rad).reshape(E, 5, C)
    f0 = x0[src]
    f1 = x1[src]
    Y1 = rhat
    p00_0 = f0 * R[:, 0, :]
    p11_0 = torch.einsum('ejc,ej->ec', f1, Y1) * R[:, 1, :]
    p01_1 = torch.einsum('ec,ej->ejc', f0, Y1) * R[:, 2, :][:, None, :]
    p10_1 = f1 * R[:, 3, :][:, None, :]
    p11_1 = torch.einsum('ijk,ekc,ej->eic', cg_eps, f1, Y1) * R[:, 4, :][:, None, :]
    m0 = torch.concatenate([p00_0, p11_0], axis=-1) @ w_si0
    m1 = torch.einsum('ejp,pc->ejc', torch.concatenate([p01_1, p10_1, p11_1], axis=-1), w_si1)
    agg0 = _segment_sum(m0, dst, N)
    agg1 = _segment_sum(m1.reshape(E, 3 * C), dst, N).reshape(N, 3, C)
    gate = _sigmoid(agg0)
    out1 = agg1 * gate[:, None, :]
    return torch.concatenate([agg0, out1.reshape(N, 3 * C)], axis=-1)
```

```asm
; @launch kernel=prep_kernel grid=(254,1,1) block=(1024,1,1) lds=40448
; @launch kernel=main_kernel grid=(256,1,1) block=(512,1,1) lds=157248
.amdgcn_target "amdgcn-amd-amdhsa--gfx950"
.text
.p2align 8
.type prep_kernel,@function
prep_kernel:
    s_cmp_ge_u32 s2, 254
    s_cbranch_scc1 P_END
    s_load_dwordx2 s[8:9], s[0:1], 32
    s_load_dwordx2 s[12:13], s[0:1], 24
    s_load_dwordx2 s[16:17], s[0:1], 8
    s_load_dwordx2 s[20:21], s[0:1], 88
    s_load_dwordx2 s[24:25], s[0:1], 40
    s_load_dwordx2 s[28:29], s[0:1], 48
    s_load_dwordx2 s[32:33], s[0:1], 56
    s_mov_b32 s10, 3200000
    s_mov_b32 s11, 0x20000
    s_mov_b32 s14, 3200000
    s_mov_b32 s15, 0x20000
    s_mov_b32 s18, 4800000
    s_mov_b32 s19, 0x20000
    s_mov_b32 s22, 16777216
    s_mov_b32 s23, 0x20000
    s_mov_b32 s26, 10240
    s_mov_b32 s27, 0x20000
    s_mov_b32 s30, 16384
    s_mov_b32 s31, 0x20000
    s_mov_b32 s34, 24576
    s_mov_b32 s35, 0x20000
    s_waitcnt lgkmcnt(0)
    s_cmp_ge_u32 s2, 250
    s_cbranch_scc1 P_WEIGHTS
    v_cmp_gt_u32 vcc, 0x100, v0
    s_and_saveexec_b64 s[40:41], vcc
    s_cbranch_execz P_L1
    v_lshlrev_b32 v1, 2, v0
    v_mov_b32 v2, 0
    ds_write_b32 v1, v2
P_L1:
    s_mov_b64 exec, s[40:41]
    v_cmp_gt_u32 vcc, 0x320, v0
    s_mov_b64 s[44:45], vcc
    s_and_saveexec_b64 s[42:43], vcc
    s_cbranch_execz P_L2
    s_mul_i32 s3, s2, 12800
    s_mul_i32 s4, s2, 19200
    v_lshl_add_u32 v1, v0, 4, s3
    v_mul_u32_u24 v2, 24, v0
    v_add_u32 v2, s4, v2
    buffer_load_dwordx4 v[4:7], v1, s[8:11], 0 offen nt
    buffer_load_dwordx4 v[8:11], v1, s[12:15], 0 offen nt
    buffer_load_dwordx4 v[12:15], v2, s[16:19], 0 offen nt
    buffer_load_dwordx2 v[16:17], v2, s[16:19], 0 offen offset:16 nt
P_L2:
    s_mov_b64 exec, s[42:43]
    s_waitcnt lgkmcnt(0)
    s_barrier
    s_mov_b64 exec, s[44:45]
    s_cbranch_execz P_L3
    s_mov_b32 s5, 21990233
    s_movk_i32 s6, 3125
    s_mul_i32 s7, s2, 3200
    v_lshl_add_u32 v3, v0, 2, s7
    v_mov_b32 v26, 1
    s_waitcnt vmcnt(3)
    v_mul_hi_u32 v18, v4, s5
    v_mul_hi_u32 v19, v5, s5
    v_mul_hi_u32 v20, v6, s5
    v_mul_hi_u32 v21, v7, s5
    v_lshlrev_b32 v44, 2, v18
    v_lshlrev_b32 v45, 2, v19
    v_lshlrev_b32 v46, 2, v20
    v_lshlrev_b32 v47, 2, v21
    ds_add_rtn_u32 v22, v44, v26
    ds_add_rtn_u32 v23, v45, v26
    ds_add_rtn_u32 v24, v46, v26
    ds_add_rtn_u32 v25, v47, v26
    v_mad_u32_u24 v48, v18, s6, 15
    v_lshrrev_b32 v48, 4, v48
    v_sub_u32 v4, v4, v48
    v_add_u32 v49, 0, v3
    v_lshl_or_b32 v30, v4, 20, v49
    v_mad_u32_u24 v48, v19, s6, 15
    v_lshrrev_b32 v48, 4, v48
    v_sub_u32 v5, v5, v48
    v_add_u32 v49, 1, v3
    v_lshl_or_b32 v34, v5, 20, v49
    v_mad_u32_u24 v48, v20, s6, 15
    v_lshrrev_b32 v48, 4, v48
    v_sub_u32 v6, v6, v48
    v_add_u32 v49, 2, v3
    v_lshl_or_b32 v38, v6, 20, v49
    v_mad_u32_u24 v48, v21, s6, 15
    v_lshrrev_b32 v48, 4, v48
    v_sub_u32 v7, v7, v48
    v_add_u32 v49, 3, v3
    v_lshl_or_b32 v42, v7, 20, v49
    s_waitcnt vmcnt(0)
    v_mov_b32 v28, v12
    v_and_b32 v48, 0xffff, v13
    v_lshl_or_b32 v29, v8, 16, v48
    v_alignbit_b32 v32, v14, v13, 16
    v_alignbit_b32 v33, v9, v14, 16
    v_mov_b32 v36, v15
    v_and_b32 v48, 0xffff, v16
    v_lshl_or_b32 v37, v10, 16, v48
    v_alignbit_b32 v40, v17, v16, 16
    v_alignbit_b32 v41, v11, v17, 16
P_L3:
    s_mov_b64 exec, -1
    s_waitcnt lgkmcnt(0)
    s_barrier
    v_cmp_gt_u32 vcc, 64, v0
    s_and_saveexec_b64 s[40:41], vcc
    s_cbranch_execz P_L4
    v_lshlrev_b32 v1, 4, v0
    ds_read_b128 v[48:51], v1
    s_waitcnt lgkmcnt(0)
    v_add_u32 v52, v48, v49
    v_add_u32 v53, v52, v50
    v_add_u32 v54, v53, v51
    v_mov_b32 v55, v54
    s_nop 1
    v_add_u32_dpp v55, v55, v55 row_shr:1 row_mask:0xf bank_mask:0xf
    s_nop 1
    v_add_u32_dpp v55, v55, v55 row_shr:2 row_mask:0xf bank_mask:0xf
    s_nop 1
    v_add_u32_dpp v55, v55, v55 row_shr:4 row_mask:0xf bank_mask:0xf
    s_nop 1
    v_add_u32_dpp v55, v55, v55 row_shr:8 row_mask:0xf bank_mask:0xf
    s_nop 1
    v_add_u32_dpp v55, v55, v55 row_bcast:15 row_mask:0xa bank_mask:0xf
    s_nop 1
    v_add_u32_dpp v55, v55, v55 row_bcast:31 row_mask:0xc bank_mask:0xf
    v_sub_u32 v56, v55, v54
    v_add_u32 v57, v56, v48
    v_add_u32 v58, v56, v52
    v_add_u32 v59, v56, v53
    ds_write_b128 v1, v[56:59] offset:1024
    v_lshl_or_b32 v60, v48, 16, v56
    v_lshl_or_b32 v61, v49, 16, v57
    v_lshl_or_b32 v62, v50, 16, v58
    v_lshl_or_b32 v63, v51, 16, v59
    s_and_b32 s3, s2, 7
    s_lshl_b32 s3, s3, 5
    s_lshr_b32 s4, s2, 3
    s_add_u32 s3, s3, s4
    s_lshl_b32 s3, s3, 2
    s_add_u32 s3, s3, 13631488
    v_lshlrev_b32 v1, 12, v0
    buffer_store_dword v60, v1, s[20:23], s3 offen
    buffer_store_dword v61, v1, s[20:23], s3 offen offset:1024
    buffer_store_dword v62, v1, s[20:23], s3 offen offset:2048
    buffer_store_dword v63, v1, s[20:23], s3 offen offset:3072
P_L4:
    s_mov_b64 exec, -1
    s_waitcnt lgkmcnt(0)
    s_barrier
    s_mov_b64 exec, s[44:45]
    s_cbranch_execz P_L5
    ds_read_b32 v48, v44 offset:1024
    ds_read_b32 v49, v45 offset:1024
    ds_read_b32 v50, v46 offset:1024
    ds_read_b32 v51, v47 offset:1024
    s_movk_i32 s6, 2048
    s_waitcnt lgkmcnt(0)
    v_add_u32 v48, v48, v22
    v_mad_u32_u24 v48, v48, 12, s6
    v_add_u32 v49, v49, v23
    v_mad_u32_u24 v49, v49, 12, s6
    v_add_u32 v50, v50, v24
    v_mad_u32_u24 v50, v50, 12, s6
    v_add_u32 v51, v51, v25
    v_mad_u32_u24 v51, v51, 12, s6
    ds_write2_b32 v48, v28, v29 offset0:0 offset1:1
    ds_write_b32 v48, v30 offset:8
    ds_write2_b32 v49, v32, v33 offset0:0 offset1:1
    ds_write_b32 v49, v34 offset:8
    ds_write2_b32 v50, v36, v37 offset0:0 offset1:1
    ds_write_b32 v50, v38 offset:8
    ds_write2_b32 v51, v40, v41 offset0:0 offset1:1
    ds_write_b32 v51, v42 offset:8
P_L5:
    s_mov_b64 exec, -1
    s_waitcnt lgkmcnt(0)
    s_barrier
    v_lshlrev_b32 v1, 4, v0
    ds_read_b128 v[4:7], v1 offset:2048
    ds_read_b128 v[8:11], v1 offset:18432
    s_mul_i32 s3, s2, 38400
    s_add_u32 s4, s3, 16384
    s_add_u32 s5, s3, 32768
    s_waitcnt lgkmcnt(1)
    buffer_store_dwordx4 v[4:7], v1, s[20:23], s3 offen sc0 sc1
    s_waitcnt lgkmcnt(0)
    buffer_store_dwordx4 v[8:11], v1, s[20:23], s4 offen sc0 sc1
    v_cmp_gt_u32 vcc, 352, v0
    s_and_saveexec_b64 s[40:41], vcc
    s_cbranch_execz P_FIN
    ds_read_b128 v[12:15], v1 offset:34816
    s_waitcnt lgkmcnt(0)
    buffer_store_dwordx4 v[12:15], v1, s[20:23], s5 offen sc0 sc1
P_FIN:
    s_mov_b64 exec, -1
    s_endpgm
P_WEIGHTS:
    v_lshrrev_b32 v1, 6, v0
    s_nop 0
    v_readfirstlane_b32 s3, v1
    s_sub_u32 s4, s2, 250
    s_lshl_b32 s4, s4, 4
    s_nop 0
    s_add_u32 s3, s3, s4
    s_cmp_ge_u32 s3, 50
    s_cbranch_scc1 P_IDLE
    v_and_b32 v1, 63, v0
    v_and_b32 v2, 15, v1
    v_lshrrev_b32 v3, 4, v1
    s_lshl_b32 s6, s3, 10
    s_add_u32 s6, s6, 14680064
    v_lshlrev_b32 v30, 4, v1
    s_cmp_ge_u32 s3, 10
    s_cbranch_scc1 P_WSI
    s_lshr_b32 s4, s3, 1
    s_and_b32 s5, s3, 1
    s_lshl_b32 s4, s4, 6
    s_lshl_b32 s5, s5, 5
    s_add_u32 s4, s4, s5
    v_and_b32 v6, 1, v3
    v_mul_u32_u24 v6, 0xa00, v6
    v_lshrrev_b32 v7, 1, v3
    v_lshl_add_u32 v4, v2, 1, v6
    v_add_u32 v4, v4, v7
    v_add_u32 v4, s4, v4
    v_lshlrev_b32 v4, 1, v4
    v_add_u32 v5, 0x1000, v4
    buffer_load_ushort v10, v4, s[24:27], 0 offen offset:0
    buffer_load_ushort v11, v4, s[24:27], 0 offen offset:640
    buffer_load_ushort v12, v4, s[24:27], 0 offen offset:1280
    buffer_load_ushort v13, v4, s[24:27], 0 offen offset:1920
    buffer_load_ushort v14, v4, s[24:27], 0 offen offset:2560
    buffer_load_ushort v15, v4, s[24:27], 0 offen offset:3200
    buffer_load_ushort v16, v4, s[24:27], 0 offen offset:3840
    buffer_load_ushort v17, v5, s[24:27], 0 offen offset:384
    s_waitcnt vmcnt(0)
    v_lshl_or_b32 v20, v11, 16, v10
    v_lshl_or_b32 v21, v13, 16, v12
    v_lshl_or_b32 v22, v15, 16, v14
    v_lshl_or_b32 v23, v17, 16, v16
    buffer_store_dwordx4 v[20:23], v30, s[20:23], s6 offen
    s_endpgm
P_WSI:
    s_sub_u32 s4, s3, 10
    s_cmp_ge_u32 s3, 26
    s_cselect_b32 s5, 16, 0
    s_sub_u32 s4, s4, s5
    s_lshr_b32 s7, s4, 2
    s_and_b32 s4, s4, 3
    s_lshr_b32 s36, s4, 1
    s_lshl_b32 s36, s36, 5
    s_and_b32 s37, s4, 1
    s_lshl_b32 s37, s37, 2
    s_add_u32 s36, s36, s37
    s_lshr_b32 s38, s7, 1
    s_lshl_b32 s38, s38, 12
    s_and_b32 s7, s7, 1
    s_lshl_b32 s7, s7, 10
    s_add_u32 s36, s36, s38
    s_add_u32 s36, s36, s7
    v_lshrrev_b32 v6, 2, v2
    v_and_b32 v7, 3, v2
    v_lshl_add_u32 v4, v6, 3, v7
    v_lshl_add_u32 v4, v3, 8, v4
    v_add_u32 v4, s36, v4
    v_lshlrev_b32 v4, 1, v4
    s_cmp_ge_u32 s3, 26
    s_cbranch_scc1 P_WSI1
    v_add_u32 v5, 0x1000, v4
    buffer_load_ushort v10, v4, s[28:31], 0 offen offset:0
    buffer_load_ushort v11, v4, s[28:31], 0 offen offset:128
    buffer_load_ushort v12, v5, s[28:31], 0 offen offset:0
    buffer_load_ushort v13, v5, s[28:31], 0 offen offset:128
    buffer_load_ushort v14, v4, s[28:31], 0 offen offset:256
    buffer_load_ushort v15, v4, s[28:31], 0 offen offset:384
    buffer_load_ushort v16, v5, s[28:31], 0 offen offset:256
    buffer_load_ushort v17, v5, s[28:31], 0 offen offset:384
    s_waitcnt vmcnt(0)
    v_lshl_or_b32 v20, v11, 16, v10
    v_lshl_or_b32 v21, v13, 16, v12
    v_lshl_or_b32 v22, v15, 16, v14
    v_lshl_or_b32 v23, v17, 16, v16
    buffer_store_dwordx4 v[20:23], v30, s[20:23], s6 offen
    s_endpgm
P_WSI1:
    v_add_u32 v5, 0x1000, v4
    buffer_load_ushort v10, v4, s[32:35], 0 offen offset:0
    buffer_load_ushort v11, v4, s[32:35], 0 offen offset:128
    buffer_load_ushort v12, v5, s[32:35], 0 offen offset:0
    buffer_load_ushort v13, v5, s[32:35], 0 offen offset:128
    buffer_load_ushort v14, v4, s[32:35], 0 offen offset:256
    buffer_load_ushort v15, v4, s[32:35], 0 offen offset:384
    buffer_load_ushort v16, v5, s[32:35], 0 offen offset:256
    buffer_load_ushort v17, v5, s[32:35], 0 offen offset:384
    s_waitcnt vmcnt(0)
    v_lshl_or_b32 v20, v11, 16, v10
    v_lshl_or_b32 v21, v13, 16, v12
    v_lshl_or_b32 v22, v15, 16, v14
    v_lshl_or_b32 v23, v17, 16, v16
    buffer_store_dwordx4 v[20:23], v30, s[20:23], s6 offen
    s_endpgm
P_IDLE:
P_END:
    s_endpgm
.p2align 8
.type main_kernel,@function
main_kernel:
    s_cmp_ge_u32 s2, 256
    s_cbranch_scc1 M_END
    s_load_dwordx2 s[8:9], s[0:1], 0
    s_load_dwordx2 s[12:13], s[0:1], 16
    s_load_dwordx2 s[16:17], s[0:1], 88
    s_load_dwordx2 s[20:21], s[0:1], 72
    s_mov_b32 s10, 25600000
    s_mov_b32 s11, 0x20000
    s_mov_b32 s14, 25600000
    s_mov_b32 s15, 0x20000
    s_mov_b32 s18, 16777216
    s_mov_b32 s19, 0x20000
    s_mov_b32 s22, 25600000
    s_mov_b32 s23, 0x20000
    v_lshrrev_b32 v2, 6, v0
    v_and_b32 v1, 63, v0
    v_readfirstlane_b32 s26, v2
    s_mul_i32 s33, s2, 3125
    s_add_u32 s24, s33, 15
    s_add_u32 s34, s33, 3140
    s_lshr_b32 s24, s24, 4
    s_lshr_b32 s34, s34, 4
    s_sub_u32 s25, s34, s24
    v_lshlrev_b32 v168, 4, v1
    s_waitcnt lgkmcnt(0)
    s_cmp_lg_u32 s26, 0
    s_cbranch_scc1 M_NOTAB
    s_lshl_b32 s33, s2, 10
    s_add_u32 s33, s33, 13631488
    buffer_load_dwordx4 v[68:71], v168, s[16:19], s33 offen
M_NOTAB:
    s_add_u32 s34, s26, 0
    s_lshl_b32 s35, s34, 10
    s_add_u32 m0, s35, 73728
    s_add_u32 s35, s35, 14680064
    buffer_load_dwordx4 v168, s[16:19], s35 offen lds
    s_add_u32 s34, s26, 8
    s_lshl_b32 s35, s34, 10
    s_mov_b32 s36, 83968
    s_cmp_lt_u32 s34, 10
    s_cselect_b32 s36, s36, 0
    s_add_u32 s36, s36, s35
    s_sub_u32 m0, s36, 10240
    s_add_u32 s35, s35, 14680064
    buffer_load_dwordx4 v168, s[16:19], s35 offen lds
    s_add_u32 s34, s26, 16
    s_lshl_b32 s35, s34, 10
    s_sub_u32 m0, s35, 10240
    s_add_u32 s35, s35, 14680064
    buffer_load_dwordx4 v168, s[16:19], s35 offen lds
    s_add_u32 s34, s26, 24
    s_lshl_b32 s35, s34, 10
    s_sub_u32 m0, s35, 10240
    s_add_u32 s35, s35, 14680064
    buffer_load_dwordx4 v168, s[16:19], s35 offen lds
    s_add_u32 s34, s26, 32
    s_lshl_b32 s35, s34, 10
    s_sub_u32 m0, s35, 10240
    s_add_u32 s35, s35, 14680064
    buffer_load_dwordx4 v168, s[16:19], s35 offen lds
    s_add_u32 s34, s26, 40
    s_lshl_b32 s35, s34, 10
    s_sub_u32 m0, s35, 10240
    s_add_u32 s35, s35, 14680064
    buffer_load_dwordx4 v168, s[16:19], s35 offen lds
    s_cmp_ge_u32 s26, 2
    s_cbranch_scc1 M_WDONE
    s_add_u32 s34, s26, 48
    s_lshl_b32 s35, s34, 10
    s_sub_u32 m0, s35, 10240
    s_add_u32 s35, s35, 14680064
    buffer_load_dwordx4 v168, s[16:19], s35 offen lds
M_WDONE:
    v_mov_b32 v108, 0
    v_mov_b32 v109, 0
    v_mov_b32 v110, 0x80000000
    v_mov_b32 v111, v110
    v_mov_b32 v112, 0
    v_mov_b32 v113, 0
    v_mov_b32 v114, 0
    v_mov_b32 v115, 0
    v_lshlrev_b32 v2, 4, v0
    v_add_u32 v3, 86016, v2
    ds_write_b128 v3, v[108:111] offset:0
    ds_write_b128 v3, v[108:111] offset:8192
    ds_write_b128 v3, v[108:111] offset:16384
    ds_write_b128 v3, v[108:111] offset:24576
    ds_write_b128 v3, v[108:111] offset:32768
    ds_write_b128 v3, v[108:111] offset:40960
    ds_write_b128 v3, v[108:111] offset:49152
    ds_write_b128 v3, v[108:111] offset:57344
    v_cmp_gt_u32 s[48:49], 64, v0
    v_add_u32 v3, 151552, v2
    v_add_u32 v2, 153600, v2
    v_cndmask_b32 v3, v2, v3, s[48:49]
    v_cmp_gt_u32 vcc, 80, v0
    s_and_saveexec_b64 s[46:47], vcc
    ds_write_b128 v3, v[112:115]
    s_mov_b64 exec, s[46:47]
    s_cmp_lg_u32 s26, 0
    s_cbranch_scc1 M_B_DONE
    v_mov_b32 v158, 0
    v_writelane_b32 v158, 24, 0
    v_writelane_b32 v158, 48, 1
    v_writelane_b32 v158, 32, 2
    v_writelane_b32 v158, 56, 3
    v_writelane_b32 v158, 0, 4
    v_writelane_b32 v158, 33, 5
    v_writelane_b32 v158, 40, 6
    v_writelane_b32 v158, 34, 7
    v_writelane_b32 v158, 41, 8
    v_writelane_b32 v158, 8, 9
    v_writelane_b32 v158, 49, 10
    v_writelane_b32 v158, 9, 11
    v_writelane_b32 v158, 16, 12
    v_writelane_b32 v158, 25, 13
    v_writelane_b32 v158, 42, 14
    v_writelane_b32 v158, 1, 15
    v_writelane_b32 v158, 43, 16
    v_writelane_b32 v158, 50, 17
    v_writelane_b32 v158, 17, 18
    v_writelane_b32 v158, 18, 19
    v_writelane_b32 v158, 26, 20
    v_writelane_b32 v158, 10, 21
    v_writelane_b32 v158, 57, 22
    v_writelane_b32 v158, 2, 23
    v_writelane_b32 v158, 3, 24
    v_writelane_b32 v158, 44, 25
    v_writelane_b32 v158, 11, 26
    v_writelane_b32 v158, 35, 27
    v_writelane_b32 v158, 51, 28
    v_writelane_b32 v158, 19, 29
    v_writelane_b32 v158, 27, 30
    v_writelane_b32 v158, 52, 31
    v_writelane_b32 v158, 4, 32
    v_writelane_b32 v158, 5, 33
    v_writelane_b32 v158, 20, 34
    v_writelane_b32 v158, 58, 35
    v_writelane_b32 v158, 21, 36
    v_writelane_b32 v158, 59, 37
    v_writelane_b32 v158, 12, 38
    v_writelane_b32 v158, 13, 39
    v_writelane_b32 v158, 22, 40
    v_writelane_b32 v158, 28, 41
    v_writelane_b32 v158, 36, 42
    v_writelane_b32 v158, 60, 43
    v_writelane_b32 v158, 14, 44
    v_writelane_b32 v158, 61, 45
    v_writelane_b32 v158, 29, 46
    v_writelane_b32 v158, 6, 47
    v_writelane_b32 v158, 30, 48
    s_waitcnt vmcnt(7)
    v_and_b32 v88, 7, v1
    v_lshrrev_b32 v89, 3, v1
    v_lshl_add_u32 v88, v88, 5, v89
    s_movk_i32 s33, 3200
    v_add_u32 v72, 0, v88
    v_lshrrev_b32 v76, 16, v68
    v_cmp_gt_u32 vcc, 250, v72
    v_and_b32 v80, 0xffff, v68
    s_nop 0
    v_cndmask_b32 v76, 0, v76, vcc
    v_mad_u32_u24 v80, v72, s33, v80
    v_add_u32 v73, 8, v88
    v_lshrrev_b32 v77, 16, v69
    v_cmp_gt_u32 vcc, 250, v73
    v_and_b32 v81, 0xffff, v69
    s_nop 0
    v_cndmask_b32 v77, 0, v77, vcc
    v_mad_u32_u24 v81, v73, s33, v81
    v_add_u32 v74, 16, v88
    v_lshrrev_b32 v78, 16, v70
    v_cmp_gt_u32 vcc, 250, v74
    v_and_b32 v82, 0xffff, v70
    s_nop 0
    v_cndmask_b32 v78, 0, v78, vcc
    v_mad_u32_u24 v82, v74, s33, v82
    v_add_u32 v75, 24, v88
    v_lshrrev_b32 v79, 16, v71
    v_cmp_gt_u32 vcc, 250, v75
    v_and_b32 v83, 0xffff, v71
    s_nop 0
    v_cndmask_b32 v79, 0, v79, vcc
    v_mad_u32_u24 v83, v75, s33, v83
    v_add_u32 v85, v76, v77
    v_add_u32 v86, v85, v78
    v_add_u32 v87, v86, v79
    v_mov_b32 v88, v87
    s_nop 1
    v_add_u32_dpp v88, v88, v88 row_shr:1 row_mask:0xf bank_mask:0xf
    s_nop 1
    v_add_u32_dpp v88, v88, v88 row_shr:2 row_mask:0xf bank_mask:0xf
    s_nop 1
    v_add_u32_dpp v88, v88, v88 row_shr:4 row_mask:0xf bank_mask:0xf
    s_nop 1
    v_add_u32_dpp v88, v88, v88 row_shr:8 row_mask:0xf bank_mask:0xf
    s_nop 1
    v_add_u32_dpp v88, v88, v88 row_bcast:15 row_mask:0xa bank_mask:0xf
    s_nop 1
    v_add_u32_dpp v88, v88, v88 row_bcast:31 row_mask:0xc bank_mask:0xf
    v_sub_u32 v89, v88, v87
    v_add_u32 v87, v89, v86
    v_add_u32 v86, v89, v85
    v_add_u32 v85, v89, v76
    v_mov_b32 v84, v89
    v_mov_b32 v92, v80
    v_and_b32 v93, 0xffff, v84
    v_lshl_or_b32 v93, v76, 16, v93
    v_mov_b32 v94, v81
    v_and_b32 v95, 0xffff, v85
    v_lshl_or_b32 v95, v77, 16, v95
    v_mov_b32 v96, v82
    v_and_b32 v97, 0xffff, v86
    v_lshl_or_b32 v97, v78, 16, v97
    v_mov_b32 v98, v83
    v_and_b32 v99, 0xffff, v87
    v_lshl_or_b32 v99, v79, 16, v99
    v_lshlrev_b32 v90, 5, v1
    v_add_u32 v90, 152576, v90
    ds_write_b128 v90, v[92:95]
    ds_write_b128 v90, v[96:99] offset:16
    v_readlane_b32 s33, v88, 63
    v_mov_b32 v90, 157184
    s_nop 0
    v_mov_b32 v91, s33
    ds_write_b32 v90, v91
M_B_DONE:
    s_waitcnt lgkmcnt(0)
    s_barrier
    v_mov_b32 v2, 157184
    ds_read_b32 v3, v2
    v_lshrrev_b32 v7, 4, v0
    v_lshlrev_b32 v7, 3, v7
    v_add_u32 v7, 152576, v7
    ds_read_b64 v[68:69], v7 offset:0
    ds_read_b64 v[70:71], v7 offset:256
    ds_read_b64 v[72:73], v7 offset:512
    ds_read_b64 v[74:75], v7 offset:768
    ds_read_b64 v[76:77], v7 offset:1024
    ds_read_b64 v[78:79], v7 offset:1280
    ds_read_b64 v[80:81], v7 offset:1536
    ds_read_b64 v[82:83], v7 offset:1792
    v_and_b32 v4, 15, v0
    s_waitcnt lgkmcnt(8)
    v_readfirstlane_b32 s27, v3
    s_waitcnt lgkmcnt(0)
    s_cmp_gt_u32 s27, 4096
    s_cbranch_scc1 M_SLOW
    v_lshrrev_b32 v12, 16, v69
    v_and_b32 v20, 0xffff, v69
    v_add_u32 v20, v20, v4
    v_lshlrev_b32 v20, 2, v20
    v_add_u32 v20, 40960, v20
    v_add_u32 v68, v68, v4
    v_lshrrev_b32 v13, 16, v71
    v_and_b32 v21, 0xffff, v71
    v_add_u32 v21, v21, v4
    v_lshlrev_b32 v21, 2, v21
    v_add_u32 v21, 40960, v21
    v_add_u32 v70, v70, v4
    v_lshrrev_b32 v14, 16, v73
    v_and_b32 v22, 0xffff, v73
    v_add_u32 v22, v22, v4
    v_lshlrev_b32 v22, 2, v22
    v_add_u32 v22, 40960, v22
    v_add_u32 v72, v72, v4
    v_lshrrev_b32 v15, 16, v75
    v_and_b32 v23, 0xffff, v75
    v_add_u32 v23, v23, v4
    v_lshlrev_b32 v23, 2, v23
    v_add_u32 v23, 40960, v23
    v_add_u32 v74, v74, v4
    v_lshrrev_b32 v16, 16, v77
    v_and_b32 v24, 0xffff, v77
    v_add_u32 v24, v24, v4
    v_lshlrev_b32 v24, 2, v24
    v_add_u32 v24, 40960, v24
    v_add_u32 v76, v76, v4
    v_lshrrev_b32 v17, 16, v79
    v_and_b32 v25, 0xffff, v79
    v_add_u32 v25, v25, v4
    v_lshlrev_b32 v25, 2, v25
    v_add_u32 v25, 40960, v25
    v_add_u32 v78, v78, v4
    v_lshrrev_b32 v18, 16, v81
    v_and_b32 v26, 0xffff, v81
    v_add_u32 v26, v26, v4
    v_lshlrev_b32 v26, 2, v26
    v_add_u32 v26, 40960, v26
    v_add_u32 v80, v80, v4
    v_lshrrev_b32 v19, 16, v83
    v_and_b32 v27, 0xffff, v83
    v_add_u32 v27, v27, v4
    v_lshlrev_b32 v27, 2, v27
    v_add_u32 v27, 40960, v27
    v_add_u32 v82, v82, v4
    v_max3_u32 v5, v12, v13, v14
    v_max3_u32 v5, v5, v15, v16
    v_max3_u32 v5, v5, v17, v18
    v_max_u32 v5, v5, v19
M_C_LOOP:
    v_cmpx_lt_u32 vcc, v4, v12
    ds_write_b32 v20, v68
    s_mov_b64 exec, -1
    v_cmpx_lt_u32 vcc, v4, v13
    ds_write_b32 v21, v70
    s_mov_b64 exec, -1
    v_cmpx_lt_u32 vcc, v4, v14
    ds_write_b32 v22, v72
    s_mov_b64 exec, -1
    v_cmpx_lt_u32 vcc, v4, v15
    ds_write_b32 v23, v74
    s_mov_b64 exec, -1
    v_cmpx_lt_u32 vcc, v4, v16
    ds_write_b32 v24, v76
    s_mov_b64 exec, -1
    v_cmpx_lt_u32 vcc, v4, v17
    ds_write_b32 v25, v78
    s_mov_b64 exec, -1
    v_cmpx_lt_u32 vcc, v4, v18
    ds_write_b32 v26, v80
    s_mov_b64 exec, -1
    v_cmpx_lt_u32 vcc, v4, v19
    ds_write_b32 v27, v82
    s_mov_b64 exec, -1
    v_add_u32 v20, 64, v20
    v_add_u32 v68, 16, v68
    v_add_u32 v21, 64, v21
    v_add_u32 v70, 16, v70
    v_add_u32 v22, 64, v22
    v_add_u32 v72, 16, v72
    v_add_u32 v23, 64, v23
    v_add_u32 v74, 16, v74
    v_add_u32 v24, 64, v24
    v_add_u32 v76, 16, v76
    v_add_u32 v25, 64, v25
    v_add_u32 v78, 16, v78
    v_add_u32 v26, 64, v26
    v_add_u32 v80, 16, v80
    v_add_u32 v27, 64, v27
    v_add_u32 v82, 16, v82
    v_add_u32 v4, 16, v4
    v_and_b32 v6, 0xfffffff0, v4
    v_cmp_gt_u32 vcc, v5, v6
    s_cbranch_vccnz M_C_LOOP
    s_waitcnt lgkmcnt(0)
    s_barrier
    v_lshlrev_b32 v2, 2, v0
    v_add_u32 v2, 40960, v2
    ds_read_b32 v68, v2 offset:0
    ds_read_b32 v69, v2 offset:2048
    ds_read_b32 v70, v2 offset:4096
    ds_read_b32 v71, v2 offset:6144
    ds_read_b32 v72, v2 offset:8192
    ds_read_b32 v73, v2 offset:10240
    ds_read_b32 v74, v2 offset:12288
    ds_read_b32 v75, v2 offset:14336
    v_add_u32 v84, 0, v0
    v_cmp_gt_u32 s[48:49], s27, v84
    v_add_u32 v85, 512, v0
    v_cmp_gt_u32 s[50:51], s27, v85
    v_add_u32 v86, 1024, v0
    v_cmp_gt_u32 s[52:53], s27, v86
    v_add_u32 v87, 1536, v0
    v_cmp_gt_u32 s[54:55], s27, v87
    v_add_u32 v88, 2048, v0
    v_cmp_gt_u32 s[56:57], s27, v88
    v_add_u32 v89, 2560, v0
    v_cmp_gt_u32 s[58:59], s27, v89
    v_add_u32 v90, 3072, v0
    v_cmp_gt_u32 s[60:61], s27, v90
    v_add_u32 v91, 3584, v0
    v_cmp_gt_u32 s[62:63], s27, v91
    v_mov_b32 v92, 1
    v_mov_b32 v93, 0x80000000
    s_waitcnt lgkmcnt(0)
    v_mul_u32_u24 v68, 12, v68
    v_cndmask_b32 v68, v93, v68, s[48:49]
    buffer_load_dwordx3 v[108:110], v68, s[16:19], 0 offen nt
    v_mul_u32_u24 v69, 12, v69
    v_cndmask_b32 v69, v93, v69, s[50:51]
    buffer_load_dwordx3 v[112:114], v69, s[16:19], 0 offen nt
    v_mul_u32_u24 v70, 12, v70
    v_cndmask_b32 v70, v93, v70, s[52:53]
    buffer_load_dwordx3 v[116:118], v70, s[16:19], 0 offen nt
    v_mul_u32_u24 v71, 12, v71
    v_cndmask_b32 v71, v93, v71, s[54:55]
    buffer_load_dwordx3 v[120:122], v71, s[16:19], 0 offen nt
    v_mul_u32_u24 v72, 12, v72
    v_cndmask_b32 v72, v93, v72, s[56:57]
    buffer_load_dwordx3 v[124:126], v72, s[16:19], 0 offen nt
    v_mul_u32_u24 v73, 12, v73
    v_cndmask_b32 v73, v93, v73, s[58:59]
    buffer_load_dwordx3 v[128:130], v73, s[16:19], 0 offen nt
    v_mul_u32_u24 v74, 12, v74
    v_cndmask_b32 v74, v93, v74, s[60:61]
    buffer_load_dwordx3 v[132:134], v74, s[16:19], 0 offen nt
    v_mul_u32_u24 v75, 12, v75
    v_cndmask_b32 v75, v93, v75, s[62:63]
    buffer_load_dwordx3 v[136:138], v75, s[16:19], 0 offen nt
    v_lshrrev_b32 v36, 4, v1
    v_and_b32 v37, 15, v1
    v_lshlrev_b32 v161, 2, v37
    v_mov_b32 v163, 0xffff0000
    v_mov_b32 v164, 0x80000000
    v_mov_b32 v173, 0xbfb8aa3b
    v_lshrrev_b32 v38, 1, v36
    v_and_b32 v39, 1, v37
    v_cmp_eq_u32 vcc, v38, v39
    v_and_b32 v38, 1, v36
    v_lshlrev_b32 v38, 4, v38
    v_mov_b32 v39, 0x40000000
    v_cndmask_b32 v162, v39, v38, vcc
    s_mul_i32 s33, s26, 5632
    s_add_u32 s33, s33, 40960
    s_movk_i32 s34, 1408
    v_lshlrev_b32 v38, 3, v37
    v_mad_u32_u24 v165, v36, s34, v38
    v_add_u32 v165, s33, v165
    v_lshrrev_b32 v38, 2, v37
    v_lshlrev_b32 v170, 3, v38
    v_lshlrev_b32 v39, 4, v36
    v_mad_u32_u24 v166, v38, s34, v39
    v_add_u32 v166, s33, v166
    v_and_b32 v38, 3, v37
    v_lshl_add_u32 v169, v38, 7, v39
    v_cmp_eq_u32 s[38:39], 0, v38
    v_cmp_eq_u32 s[40:41], 1, v38
    v_cmp_eq_u32 s[42:43], 2, v38
    v_cmp_eq_u32 s[44:45], 3, v38
    v_max_u32 v38, 1, v38
    s_movk_i32 s34, 384
    v_mad_u32_u24 v167, v38, s34, v166
    v_subrev_u32 v167, 128, v167
    s_waitcnt vmcnt(7)
    v_lshrrev_b32 v84, 20, v110
    v_lshlrev_b32 v84, 2, v84
    v_add_u32 v84, 151552, v84
    s_mov_b64 exec, s[48:49]
    ds_add_rtn_u32 v76, v84, v92
    s_mov_b64 exec, -1
    s_waitcnt vmcnt(6)
    v_lshrrev_b32 v85, 20, v114
    v_lshlrev_b32 v85, 2, v85
    v_add_u32 v85, 151552, v85
    s_mov_b64 exec, s[50:51]
    ds_add_rtn_u32 v77, v85, v92
    s_mov_b64 exec, -1
    s_waitcnt vmcnt(5)
    v_lshrrev_b32 v86, 20, v118
    v_lshlrev_b32 v86, 2, v86
    v_add_u32 v86, 151552, v86
    s_mov_b64 exec, s[52:53]
    ds_add_rtn_u32 v78, v86, v92
    s_mov_b64 exec, -1
    s_waitcnt vmcnt(4)
    v_lshrrev_b32 v87, 20, v122
    v_lshlrev_b32 v87, 2, v87
    v_add_u32 v87, 151552, v87
    s_mov_b64 exec, s[54:55]
    ds_add_rtn_u32 v79, v87, v92
    s_mov_b64 exec, -1
    s_waitcnt vmcnt(3)
    v_lshrrev_b32 v88, 20, v126
    v_lshlrev_b32 v88, 2, v88
    v_add_u32 v88, 151552, v88
    s_mov_b64 exec, s[56:57]
    ds_add_rtn_u32 v80, v88, v92
    s_mov_b64 exec, -1
    s_waitcnt vmcnt(2)
    v_lshrrev_b32 v89, 20, v130
    v_lshlrev_b32 v89, 2, v89
    v_add_u32 v89, 151552, v89
    s_mov_b64 exec, s[58:59]
    ds_add_rtn_u32 v81, v89, v92
    s_mov_b64 exec, -1
    s_waitcnt vmcnt(1)
    v_lshrrev_b32 v90, 20, v134
    v_lshlrev_b32 v90, 2, v90
    v_add_u32 v90, 151552, v90
    s_mov_b64 exec, s[60:61]
    ds_add_rtn_u32 v82, v90, v92
    s_mov_b64 exec, -1
    s_waitcnt vmcnt(0)
    v_lshrrev_b32 v91, 20, v138
    v_lshlrev_b32 v91, 2, v91
    v_add_u32 v91, 151552, v91
    s_mov_b64 exec, s[62:63]
    ds_add_rtn_u32 v83, v91, v92
    s_mov_b64 exec, -1
    v_and_b32 v111, 0xfffff, v110
    v_lshlrev_b32 v111, 5, v111
    v_lshrrev_b32 v110, 16, v109
    v_lshlrev_b32 v110, 9, v110
    v_and_b32 v115, 0xfffff, v114
    v_lshlrev_b32 v115, 5, v115
    v_lshrrev_b32 v114, 16, v113
    v_lshlrev_b32 v114, 9, v114
    v_and_b32 v119, 0xfffff, v118
    v_lshlrev_b32 v119, 5, v119
    v_lshrrev_b32 v118, 16, v117
    v_lshlrev_b32 v118, 9, v118
    v_and_b32 v123, 0xfffff, v122
    v_lshlrev_b32 v123, 5, v123
    v_lshrrev_b32 v122, 16, v121
    v_lshlrev_b32 v122, 9, v122
    v_and_b32 v127, 0xfffff, v126
    v_lshlrev_b32 v127, 5, v127
    v_lshrrev_b32 v126, 16, v125
    v_lshlrev_b32 v126, 9, v126
    v_and_b32 v131, 0xfffff, v130
    v_lshlrev_b32 v131, 5, v131
    v_lshrrev_b32 v130, 16, v129
    v_lshlrev_b32 v130, 9, v130
    v_and_b32 v135, 0xfffff, v134
    v_lshlrev_b32 v135, 5, v135
    v_lshrrev_b32 v134, 16, v133
    v_lshlrev_b32 v134, 9, v134
    v_and_b32 v139, 0xfffff, v138
    v_lshlrev_b32 v139, 5, v139
    v_lshrrev_b32 v138, 16, v137
    v_lshlrev_b32 v138, 9, v138
    s_waitcnt lgkmcnt(0)
    s_barrier
    v_add_u32 v2, 73728, v168
    ds_read_b128 a[0:3], v2 offset:0
    ds_read_b128 a[4:7], v2 offset:1024
    ds_read_b128 a[8:11], v2 offset:2048
    ds_read_b128 a[12:15], v2 offset:3072
    ds_read_b128 a[16:19], v2 offset:4096
    ds_read_b128 a[20:23], v2 offset:5120
    ds_read_b128 a[24:27], v2 offset:6144
    ds_read_b128 a[28:31], v2 offset:7168
    ds_read_b128 a[32:35], v2 offset:8192
    ds_read_b128 a[36:39], v2 offset:9216
    s_cmp_lg_u32 s26, 0
    s_cbranch_scc1 M_D_DONE
    v_add_u32 v20, 151552, v168
    ds_read_b128 v[4:7], v20
    v_mov_b32 v24, 1
    v_cmp_gt_u32 s[46:47], 49, v1
    s_waitcnt lgkmcnt(0)
    v_min_u32 v8, 63, v4
    v_sub_u32 v8, 63, v8
    v_lshlrev_b32 v8, 2, v8
    v_add_u32 v8, 154624, v8
    v_min_u32 v9, 63, v5
    v_sub_u32 v9, 63, v9
    v_lshlrev_b32 v9, 2, v9
    v_add_u32 v9, 154624, v9
    v_min_u32 v10, 63, v6
    v_sub_u32 v10, 63, v10
    v_lshlrev_b32 v10, 2, v10
    v_add_u32 v10, 154624, v10
    v_min_u32 v11, 63, v7
    v_sub_u32 v11, 63, v11
    v_lshlrev_b32 v11, 2, v11
    v_add_u32 v11, 154624, v11
    s_mov_b64 exec, s[46:47]
    ds_add_rtn_u32 v12, v8, v24
    ds_add_rtn_u32 v13, v9, v24
    ds_add_rtn_u32 v14, v10, v24
    ds_add_rtn_u32 v15, v11, v24
    s_mov_b64 exec, -1
    v_lshlrev_b32 v20, 2, v1
    v_add_u32 v21, 154624, v20
    ds_read_b32 v22, v21
    s_waitcnt lgkmcnt(0)
    v_mov_b32 v23, v22
    s_nop 1
    v_add_u32_dpp v23, v23, v23 row_shr:1 row_mask:0xf bank_mask:0xf
    s_nop 1
    v_add_u32_dpp v23, v23, v23 row_shr:2 row_mask:0xf bank_mask:0xf
    s_nop 1
    v_add_u32_dpp v23, v23, v23 row_shr:4 row_mask:0xf bank_mask:0xf
    s_nop 1
    v_add_u32_dpp v23, v23, v23 row_shr:8 row_mask:0xf bank_mask:0xf
    s_nop 1
    v_add_u32_dpp v23, v23, v23 row_bcast:15 row_mask:0xa bank_mask:0xf
    s_nop 1
    v_add_u32_dpp v23, v23, v23 row_bcast:31 row_mask:0xc bank_mask:0xf
    v_sub_u32 v23, v23, v22
    ds_write_b32 v21, v23 offset:256
    s_mov_b64 exec, s[46:47]
    ds_read_b32 v16, v8 offset:256
    ds_read_b32 v17, v9 offset:256
    ds_read_b32 v18, v10 offset:256
    ds_read_b32 v19, v11 offset:256
    s_waitcnt lgkmcnt(0)
    v_add_u32 v12, v12, v16
    v_lshlrev_b32 v12, 2, v12
    v_add_u32 v12, 155136, v12
    v_lshl_add_u32 v22, v1, 2, 0
    v_cmp_gt_u32 vcc, s25, v22
    v_mov_b32 v23, 0xff
    s_nop 0
    v_cndmask_b32 v22, v23, v22, vcc
    v_lshl_or_b32 v16, v4, 8, v22
    ds_write_b32 v12, v16
    v_add_u32 v13, v13, v17
    v_lshlrev_b32 v13, 2, v13
    v_add_u32 v13, 155136, v13
    v_lshl_add_u32 v22, v1, 2, 1
    v_cmp_gt_u32 vcc, s25, v22
    v_mov_b32 v23, 0xff
    s_nop 0
    v_cndmask_b32 v22, v23, v22, vcc
    v_lshl_or_b32 v17, v5, 8, v22
    ds_write_b32 v13, v17
    v_add_u32 v14, v14, v18
    v_lshlrev_b32 v14, 2, v14
    v_add_u32 v14, 155136, v14
    v_lshl_add_u32 v22, v1, 2, 2
    v_cmp_gt_u32 vcc, s25, v22
    v_mov_b32 v23, 0xff
    s_nop 0
    v_cndmask_b32 v22, v23, v22, vcc
    v_lshl_or_b32 v18, v6, 8, v22
    ds_write_b32 v14, v18
    v_add_u32 v15, v15, v19
    v_lshlrev_b32 v15, 2, v15
    v_add_u32 v15, 155136, v15
    v_lshl_add_u32 v22, v1, 2, 3
    v_cmp_gt_u32 vcc, s25, v22
    v_mov_b32 v23, 0xff
    s_nop 0
    v_cndmask_b32 v22, v23, v22, vcc
    v_lshl_or_b32 v19, v7, 8, v22
    ds_write_b32 v15, v19
    v_add_u32 v20, 155136, v168
    ds_read_b128 v[16:19], v20
    s_mov_b64 exec, -1
    v_and_b32 v21, 7, v1
    v_cmp_eq_u32 vcc, 7, v21
    v_mov_b32 v22, 4
    v_lshlrev_b32 v23, 2, v1
    v_cndmask_b32 v22, 0, v22, vcc
    v_add_u32 v23, 156160, v23
    ds_write_b32 v23, v22
    s_mov_b64 exec, s[46:47]
    s_waitcnt lgkmcnt(0)
    v_max_u32 v26, v16, v17
    v_max3_u32 v26, v26, v18, v19
    v_lshrrev_b32 v26, 8, v26
    v_add_u32 v26, 1, v26
    v_and_b32 v26, 0xfffffffe, v26
    v_and_b32 v16, 0xff, v16
    v_and_b32 v17, 0xff, v17
    v_and_b32 v18, 0xff, v18
    v_and_b32 v19, 0xff, v19
    v_lshl_or_b32 v27, v17, 8, v16
    v_lshl_or_b32 v27, v18, 16, v27
    v_lshl_or_b32 v27, v19, 24, v27
    v_mov_b32 v25, v158
    v_lshlrev_b32 v20, 2, v25
    v_add_u32 v20, 156160, v20
    ds_write_b32 v20, v26
    v_lshlrev_b32 v21, 3, v25
    v_add_u32 v21, 156672, v21
    ds_write2_b32 v21, v26, v27 offset0:0 offset1:1
    s_mov_b64 exec, -1
    ds_read_b32 v22, v23
    s_waitcnt lgkmcnt(0)
    v_mov_b32 v21, v22
    s_nop 1
    v_add_u32_dpp v21, v21, v21 row_shr:1 row_mask:0xf bank_mask:0xf
    s_nop 1
    v_add_u32_dpp v21, v21, v21 row_shr:2 row_mask:0xf bank_mask:0xf
    s_nop 1
    v_add_u32_dpp v21, v21, v21 row_shr:4 row_mask:0xf bank_mask:0xf
    s_nop 1
    v_add_u32_dpp v21, v21, v21 row_shr:8 row_mask:0xf bank_mask:0xf
    s_nop 1
    v_add_u32_dpp v21, v21, v21 row_bcast:15 row_mask:0xa bank_mask:0xf
    s_nop 1
    v_add_u32_dpp v21, v21, v21 row_bcast:31 row_mask:0xc bank_mask:0xf
    v_sub_u32 v22, v21, v22
    ds_write_b32 v23, v22 offset:256
    v_readlane_b32 s33, v21, 63
    v_mov_b32 v21, 157184
    s_nop 0
    v_mov_b32 v22, s33
    ds_write_b32 v21, v22 offset:4
    s_mov_b64 exec, s[46:47]
    ds_read_b32 v22, v20 offset:256
    s_waitcnt lgkmcnt(0)
    v_lshlrev_b32 v22, 6, v22
    v_add_u32 v22, 86016, v22
    v_lshlrev_b32 v16, 2, v16
    v_add_u32 v16, 151552, v16
    v_add_u32 v21, 0, v22
    ds_write_b32 v16, v21
    v_lshlrev_b32 v17, 2, v17
    v_add_u32 v17, 151552, v17
    v_add_u32 v21, 16, v22
    ds_write_b32 v17, v21
    v_lshlrev_b32 v18, 2, v18
    v_add_u32 v18, 151552, v18
    v_add_u32 v21, 32, v22
    ds_write_b32 v18, v21
    v_lshlrev_b32 v19, 2, v19
    v_add_u32 v19, 151552, v19
    v_add_u32 v21, 48, v22
    ds_write_b32 v19, v21
    s_mov_b64 exec, -1
M_D_DONE:
    s_waitcnt vmcnt(0) lgkmcnt(0)
    s_barrier
    v_mov_b32 v2, 157184
    ds_read_b32 v3, v2 offset:4
    ds_read_b32 v94, v84
    ds_read_b32 v95, v85
    ds_read_b32 v96, v86
    ds_read_b32 v97, v87
    ds_read_b32 v98, v88
    ds_read_b32 v99, v89
    ds_read_b32 v100, v90
    ds_read_b32 v101, v91
    s_lshl_b32 s33, s26, 6
    v_and_b32 v40, 7, v1
    v_lshlrev_b32 v40, 3, v40
    v_add_u32 v40, s33, v40
    v_add_u32 v40, 156672, v40
    ds_read2_b32 v[42:43], v40 offset0:0 offset1:1
    s_lshl_b32 s33, s26, 5
    s_add_u32 s33, s33, 156416
    v_mov_b32 v40, s33
    ds_read_b32 v44, v40
    s_waitcnt lgkmcnt(10)
    v_readfirstlane_b32 s33, v3
    s_waitcnt lgkmcnt(2)
    s_cmp_gt_u32 s33, 1024
    s_cbranch_scc1 M_SLOW
    v_lshl_add_u32 v94, v76, 6, v94
    s_mov_b64 exec, s[48:49]
    ds_write_b128 v94, v[108:111]
    s_mov_b64 exec, -1
    v_lshl_add_u32 v95, v77, 6, v95
    s_mov_b64 exec, s[50:51]
    ds_write_b128 v95, v[112:115]
    s_mov_b64 exec, -1
    v_lshl_add_u32 v96, v78, 6, v96
    s_mov_b64 exec, s[52:53]
    ds_write_b128 v96, v[116:119]
    s_mov_b64 exec, -1
    v_lshl_add_u32 v97, v79, 6, v97
    s_mov_b64 exec, s[54:55]
    ds_write_b128 v97, v[120:123]
    s_mov_b64 exec, -1
    v_lshl_add_u32 v98, v80, 6, v98
    s_mov_b64 exec, s[56:57]
    ds_write_b128 v98, v[124:127]
    s_mov_b64 exec, -1
    v_lshl_add_u32 v99, v81, 6, v99
    s_mov_b64 exec, s[58:59]
    ds_write_b128 v99, v[128:131]
    s_mov_b64 exec, -1
    v_lshl_add_u32 v100, v82, 6, v100
    s_mov_b64 exec, s[60:61]
    ds_write_b128 v100, v[132:135]
    s_mov_b64 exec, -1
    v_lshl_add_u32 v101, v83, 6, v101
    s_mov_b64 exec, s[62:63]
    ds_write_b128 v101, v[136:139]
    s_mov_b64 exec, -1
    s_lshl_b32 s32, s26, 2
    s_lshr_b32 s32, 0x65557777, s32
    s_and_b32 s32, s32, 15
    s_mov_b32 s29, 0
    s_waitcnt lgkmcnt(8)
    v_mov_b32 v171, v42
    v_mov_b32 v172, v43
    v_lshlrev_b32 v44, 6, v44
    v_add_u32 v44, 86016, v44
    v_lshl_add_u32 v159, v36, 4, v44
    v_lshrrev_b32 v38, 2, v37
    v_lshl_add_u32 v160, v38, 4, v44
    v_bfe_u32 v38, v37, 1, 1
    v_lshl_add_u32 v160, v38, 6, v160
    v_readlane_b32 s28, v171, 0
    s_nop 0
    s_and_b32 s28, s28, 0x7fe
    s_waitcnt vmcnt(0) lgkmcnt(0)
    s_barrier
    ds_read_b32 v154, v160 offset:12
    ds_read_b32 v152, v159 offset:8
    ds_read_b32 v153, v159 offset:72
    s_waitcnt lgkmcnt(0)
    v_add_u32 v158, v154, v162
    v_add_u32 v156, v152, v161
    v_add_u32 v157, v153, v161
    buffer_load_dwordx4 v[140:143], v158, s[12:15], 0 offen
    buffer_load_dword v108, v156, s[8:11], 0 offen offset:0
    buffer_load_dword v110, v156, s[8:11], 0 offen offset:128
    buffer_load_dword v112, v156, s[8:11], 0 offen offset:256
    buffer_load_dword v114, v156, s[8:11], 0 offen offset:384
    buffer_load_dword v109, v156, s[8:11], 0 offen offset:64
    buffer_load_dword v111, v156, s[8:11], 0 offen offset:192
    buffer_load_dword v113, v156, s[8:11], 0 offen offset:320
    buffer_load_dword v115, v156, s[8:11], 0 offen offset:448
    buffer_load_dword v116, v157, s[8:11], 0 offen offset:0
    buffer_load_dword v118, v157, s[8:11], 0 offen offset:128
    buffer_load_dword v120, v157, s[8:11], 0 offen offset:256
    buffer_load_dword v122, v157, s[8:11], 0 offen offset:384
    buffer_load_dword v117, v157, s[8:11], 0 offen offset:64
    buffer_load_dword v119, v157, s[8:11], 0 offen offset:192
    buffer_load_dword v121, v157, s[8:11], 0 offen offset:320
    buffer_load_dword v123, v157, s[8:11], 0 offen offset:448
    ds_read_b32 v154, v160 offset:140
    ds_read_b32 v152, v159 offset:136
    ds_read_b32 v153, v159 offset:200
    s_waitcnt lgkmcnt(0)
    v_add_u32 v158, v154, v162
    v_add_u32 v156, v152, v161
    v_add_u32 v157, v153, v161
    buffer_load_dwordx4 v[144:147], v158, s[12:15], 0 offen
    buffer_load_dword v124, v156, s[8:11], 0 offen offset:0
    buffer_load_dword v126, v156, s[8:11], 0 offen offset:128
    buffer_load_dword v128, v156, s[8:11], 0 offen offset:256
    buffer_load_dword v130, v156, s[8:11], 0 offen offset:384
    buffer_load_dword v125, v156, s[8:11], 0 offen offset:64
    buffer_load_dword v127, v156, s[8:11], 0 offen offset:192
    buffer_load_dword v129, v156, s[8:11], 0 offen offset:320
    buffer_load_dword v131, v156, s[8:11], 0 offen offset:448
    buffer_load_dword v132, v157, s[8:11], 0 offen offset:0
    buffer_load_dword v134, v157, s[8:11], 0 offen offset:128
    buffer_load_dword v136, v157, s[8:11], 0 offen offset:256
    buffer_load_dword v138, v157, s[8:11], 0 offen offset:384
    buffer_load_dword v133, v157, s[8:11], 0 offen offset:64
    buffer_load_dword v135, v157, s[8:11], 0 offen offset:192
    buffer_load_dword v137, v157, s[8:11], 0 offen offset:320
    buffer_load_dword v139, v157, s[8:11], 0 offen offset:448
    v_pk_mov_b32 v[4:5], 0, 0
    v_pk_mov_b32 v[6:7], 0, 0
    v_pk_mov_b32 v[8:9], 0, 0
    v_pk_mov_b32 v[10:11], 0, 0
    v_pk_mov_b32 v[12:13], 0, 0
    v_pk_mov_b32 v[14:15], 0, 0
    v_pk_mov_b32 v[16:17], 0, 0
    v_pk_mov_b32 v[18:19], 0, 0
    v_pk_mov_b32 v[20:21], 0, 0
    v_pk_mov_b32 v[22:23], 0, 0
    v_pk_mov_b32 v[24:25], 0, 0
    v_pk_mov_b32 v[26:27], 0, 0
    v_pk_mov_b32 v[28:29], 0, 0
    v_pk_mov_b32 v[30:31], 0, 0
    v_pk_mov_b32 v[32:33], 0, 0
    v_pk_mov_b32 v[34:35], 0, 0
    v_pk_mov_b32 v[36:37], 0, 0
    v_pk_mov_b32 v[38:39], 0, 0
    v_pk_mov_b32 v[40:41], 0, 0
    v_pk_mov_b32 v[42:43], 0, 0
    v_pk_mov_b32 v[44:45], 0, 0
    v_pk_mov_b32 v[46:47], 0, 0
    s_sub_u32 s28, s28, 2
    s_cbranch_scc0 M_LOOP
    s_call_b64 s[30:31], M_POST
M_LOOP:
    ds_read_b64 v[148:149], v159 offset:0
    ds_read_b64 v[150:151], v159 offset:64
    ds_read_b32 v154, v160 offset:268
    ds_read_b32 v152, v159 offset:264
    ds_read_b32 v153, v159 offset:328
    s_waitcnt vmcnt(33)
    v_mfma_f32_16x16x32_bf16 v[68:71], v[140:143], a[0:3], 0
    v_mfma_f32_16x16x32_bf16 v[84:87], v[140:143], a[16:19], 0
    v_mfma_f32_16x16x32_bf16 v[76:79], v[140:143], a[8:11], 0
    v_mfma_f32_16x16x32_bf16 v[92:95], v[140:143], a[24:27], 0
    v_mfma_f32_16x16x32_bf16 v[100:103], v[140:143], a[32:35], 0
    v_mfma_f32_16x16x32_bf16 v[72:75], v[140:143], a[4:7], 0
    v_mfma_f32_16x16x32_bf16 v[88:91], v[140:143], a[20:23], 0
    v_mfma_f32_16x16x32_bf16 v[80:83], v[140:143], a[12:15], 0
    v_mfma_f32_16x16x32_bf16 v[96:99], v[140:143], a[28:31], 0
    v_mfma_f32_16x16x32_bf16 v[104:107], v[140:143], a[36:39], 0
    s_waitcnt lgkmcnt(0)
    v_add_u32 v158, v154, v162
    v_add_u32 v156, v152, v161
    v_add_u32 v157, v153, v161
    buffer_load_dwordx4 v[140:143], v158, s[12:15], 0 offen nt
    v_lshlrev_b32 v48, 16, v148
    v_and_b32 v49, v163, v148
    v_lshlrev_b32 v50, 16, v149
    s_waitcnt vmcnt(26)
    v_lshlrev_b32 v54, 16, v108
    v_and_b32 v55, v163, v108
    v_lshlrev_b32 v56, 16, v110
    v_and_b32 v57, v163, v110
    v_lshlrev_b32 v58, 16, v112
    v_and_b32 v59, v163, v112
    v_lshlrev_b32 v60, 16, v114
    v_and_b32 v61, v163, v114
    buffer_load_dword v108, v156, s[8:11], 0 offen offset:0
    buffer_load_dword v110, v156, s[8:11], 0 offen offset:128
    buffer_load_dword v112, v156, s[8:11], 0 offen offset:256
    buffer_load_dword v114, v156, s[8:11], 0 offen offset:384
    v_pk_fma_f32 v[4:5], v[54:55], v[68:69], v[4:5]
    v_pk_mul_f32 v[62:63], v[54:55], v[84:85]
    v_pk_mul_f32 v[64:65], v[56:57], v[48:49] op_sel:[0,0] op_sel_hi:[1,0]
    v_pk_fma_f32 v[12:13], v[62:63], v[48:49], v[12:13] op_sel:[0,0,0] op_sel_hi:[1,0,1]
    v_pk_fma_f32 v[64:65], v[58:59], v[48:49], v[64:65] op_sel:[0,1,0] op_sel_hi:[1,1,1]
    v_pk_fma_f32 v[16:17], v[62:63], v[48:49], v[16:17] op_sel:[0,1,0] op_sel_hi:[1,1,1]
    v_pk_fma_f32 v[64:65], v[60:61], v[50:51], v[64:65] op_sel:[0,0,0] op_sel_hi:[1,0,1]
    v_pk_fma_f32 v[20:21], v[62:63], v[50:51], v[20:21] op_sel:[0,0,0] op_sel_hi:[1,0,1]
    v_pk_mul_f32 v[66:67], v[56:57], v[100:101]
    v_pk_mul_f32 v[174:175], v[58:59], v[100:101]
    v_pk_mul_f32 v[176:177], v[60:61], v[100:101]
    v_pk_fma_f32 v[8:9], v[64:65], v[76:77], v[8:9]
    v_pk_fma_f32 v[24:25], v[56:57], v[92:93], v[24:25]
    v_pk_fma_f32 v[28:29], v[58:59], v[92:93], v[28:29]
    v_pk_fma_f32 v[32:33], v[60:61], v[92:93], v[32:33]
    v_pk_fma_f32 v[36:37], v[176:177], v[48:49], v[36:37] op_sel:[0,1,0] op_sel_hi:[1,1,1]
    v_pk_fma_f32 v[40:41], v[66:67], v[50:51], v[40:41] op_sel:[0,0,0] op_sel_hi:[1,0,1]
    v_pk_fma_f32 v[44:45], v[174:175], v[48:49], v[44:45] op_sel:[0,0,0] op_sel_hi:[1,0,1]
    v_pk_fma_f32 v[36:37], v[174:175], v[50:51], v[36:37] op_sel:[0,0,0] op_sel_hi:[1,0,1] neg_lo:[0,1,0] neg_hi:[0,1,0]
    v_pk_fma_f32 v[40:41], v[176:177], v[48:49], v[40:41] op_sel:[0,0,0] op_sel_hi:[1,0,1] neg_lo:[0,1,0] neg_hi:[0,1,0]
    v_pk_fma_f32 v[44:45], v[66:67], v[48:49], v[44:45] op_sel:[0,1,0] op_sel_hi:[1,1,1] neg_lo:[0,1,0] neg_hi:[0,1,0]
    v_lshlrev_b32 v54, 16, v109
    v_and_b32 v55, v163, v109
    v_lshlrev_b32 v56, 16, v111
    v_and_b32 v57, v163, v111
    v_lshlrev_b32 v58, 16, v113
    v_and_b32 v59, v163, v113
    v_lshlrev_b32 v60, 16, v115
    v_and_b32 v61, v163, v115
    buffer_load_dword v109, v156, s[8:11], 0 offen offset:64
    buffer_load_dword v111, v156, s[8:11], 0 offen offset:192
    buffer_load_dword v113, v156, s[8:11], 0 offen offset:320
    buffer_load_dword v115, v156, s[8:11], 0 offen offset:448
    v_pk_fma_f32 v[6:7], v[54:55], v[72:73], v[6:7]
    v_pk_mul_f32 v[62:63], v[54:55], v[88:89]
    v_pk_mul_f32 v[64:65], v[56:57], v[48:49] op_sel:[0,0] op_sel_hi:[1,0]
    v_pk_fma_f32 v[14:15], v[62:63], v[48:49], v[14:15] op_sel:[0,0,0] op_sel_hi:[1,0,1]
    v_pk_fma_f32 v[64:65], v[58:59], v[48:49], v[64:65] op_sel:[0,1,0] op_sel_hi:[1,1,1]
    v_pk_fma_f32 v[18:19], v[62:63], v[48:49], v[18:19] op_sel:[0,1,0] op_sel_hi:[1,1,1]
    v_pk_fma_f32 v[64:65], v[60:61], v[50:51], v[64:65] op_sel:[0,0,0] op_sel_hi:[1,0,1]
    v_pk_fma_f32 v[22:23], v[62:63], v[50:51], v[22:23] op_sel:[0,0,0] op_sel_hi:[1,0,1]
    v_pk_mul_f32 v[66:67], v[56:57], v[104:105]
    v_pk_mul_f32 v[174:175], v[58:59], v[104:105]
    v_pk_mul_f32 v[176:177], v[60:61], v[104:105]
    v_pk_fma_f32 v[10:11], v[64:65], v[80:81], v[10:11]
    v_pk_fma_f32 v[26:27], v[56:57], v[96:97], v[26:27]
    v_pk_fma_f32 v[30:31], v[58:59], v[96:97], v[30:31]
    v_pk_fma_f32 v[34:35], v[60:61], v[96:97], v[34:35]
    v_pk_fma_f32 v[38:39], v[176:177], v[48:49], v[38:39] op_sel:[0,1,0] op_sel_hi:[1,1,1]
    v_pk_fma_f32 v[42:43], v[66:67], v[50:51], v[42:43] op_sel:[0,0,0] op_sel_hi:[1,0,1]
    v_pk_fma_f32 v[46:47], v[174:175], v[48:49], v[46:47] op_sel:[0,0,0] op_sel_hi:[1,0,1]
    v_pk_fma_f32 v[38:39], v[174:175], v[50:51], v[38:39] op_sel:[0,0,0] op_sel_hi:[1,0,1] neg_lo:[0,1,0] neg_hi:[0,1,0]
    v_pk_fma_f32 v[42:43], v[176:177], v[48:49], v[42:43] op_sel:[0,0,0] op_sel_hi:[1,0,1] neg_lo:[0,1,0] neg_hi:[0,1,0]
    v_pk_fma_f32 v[46:47], v[66:67], v[48:49], v[46:47] op_sel:[0,1,0] op_sel_hi:[1,1,1] neg_lo:[0,1,0] neg_hi:[0,1,0]
    v_lshlrev_b32 v48, 16, v150
    v_and_b32 v49, v163, v150
    v_lshlrev_b32 v50, 16, v151
    s_waitcnt vmcnt(26)
    v_lshlrev_b32 v54, 16, v116
    v_and_b32 v55, v163, v116
    v_lshlrev_b32 v56, 16, v118
    v_and_b32 v57, v163, v118
    v_lshlrev_b32 v58, 16, v120
    v_and_b32 v59, v163, v120
    v_lshlrev_b32 v60, 16, v122
    v_and_b32 v61, v163, v122
    buffer_load_dword v116, v157, s[8:11], 0 offen offset:0
    buffer_load_dword v118, v157, s[8:11], 0 offen offset:128
    buffer_load_dword v120, v157, s[8:11], 0 offen offset:256
    buffer_load_dword v122, v157, s[8:11], 0 offen offset:384
    v_pk_fma_f32 v[4:5], v[54:55], v[70:71], v[4:5]
    v_pk_mul_f32 v[62:63], v[54:55], v[86:87]
    v_pk_mul_f32 v[64:65], v[56:57], v[48:49] op_sel:[0,0] op_sel_hi:[1,0]
    v_pk_fma_f32 v[12:13], v[62:63], v[48:49], v[12:13] op_sel:[0,0,0] op_sel_hi:[1,0,1]
    v_pk_fma_f32 v[64:65], v[58:59], v[48:49], v[64:65] op_sel:[0,1,0] op_sel_hi:[1,1,1]
    v_pk_fma_f32 v[16:17], v[62:63], v[48:49], v[16:17] op_sel:[0,1,0] op_sel_hi:[1,1,1]
    v_pk_fma_f32 v[64:65], v[60:61], v[50:51], v[64:65] op_sel:[0,0,0] op_sel_hi:[1,0,1]
    v_pk_fma_f32 v[20:21], v[62:63], v[50:51], v[20:21] op_sel:[0,0,0] op_sel_hi:[1,0,1]
    v_pk_mul_f32 v[66:67], v[56:57], v[102:103]
    v_pk_mul_f32 v[174:175], v[58:59], v[102:103]
    v_pk_mul_f32 v[176:177], v[60:61], v[102:103]
    v_pk_fma_f32 v[8:9], v[64:65], v[78:79], v[8:9]
    v_pk_fma_f32 v[24:25], v[56:57], v[94:95], v[24:25]
    v_pk_fma_f32 v[28:29], v[58:59], v[94:95], v[28:29]
    v_pk_fma_f32 v[32:33], v[60:61], v[94:95], v[32:33]
    v_pk_fma_f32 v[36:37], v[176:177], v[48:49], v[36:37] op_sel:[0,1,0] op_sel_hi:[1,1,1]
    v_pk_fma_f32 v[40:41], v[66:67], v[50:51], v[40:41] op_sel:[0,0,0] op_sel_hi:[1,0,1]
    v_pk_fma_f32 v[44:45], v[174:175], v[48:49], v[44:45] op_sel:[0,0,0] op_sel_hi:[1,0,1]
    v_pk_fma_f32 v[36:37], v[174:175], v[50:51], v[36:37] op_sel:[0,0,0] op_sel_hi:[1,0,1] neg_lo:[0,1,0] neg_hi:[0,1,0]
    v_pk_fma_f32 v[40:41], v[176:177], v[48:49], v[40:41] op_sel:[0,0,0] op_sel_hi:[1,0,1] neg_lo:[0,1,0] neg_hi:[0,1,0]
    v_pk_fma_f32 v[44:45], v[66:67], v[48:49], v[44:45] op_sel:[0,1,0] op_sel_hi:[1,1,1] neg_lo:[0,1,0] neg_hi:[0,1,0]
    v_lshlrev_b32 v54, 16, v117
    v_and_b32 v55, v163, v117
    v_lshlrev_b32 v56, 16, v119
    v_and_b32 v57, v163, v119
    v_lshlrev_b32 v58, 16, v121
    v_and_b32 v59, v163, v121
    v_lshlrev_b32 v60, 16, v123
    v_and_b32 v61, v163, v123
    buffer_load_dword v117, v157, s[8:11], 0 offen offset:64
    buffer_load_dword v119, v157, s[8:11], 0 offen offset:192
    buffer_load_dword v121, v157, s[8:11], 0 offen offset:320
    buffer_load_dword v123, v157, s[8:11], 0 offen offset:448
    v_pk_fma_f32 v[6:7], v[54:55], v[74:75], v[6:7]
    v_pk_mul_f32 v[62:63], v[54:55], v[90:91]
    v_pk_mul_f32 v[64:65], v[56:57], v[48:49] op_sel:[0,0] op_sel_hi:[1,0]
    v_pk_fma_f32 v[14:15], v[62:63], v[48:49], v[14:15] op_sel:[0,0,0] op_sel_hi:[1,0,1]
    v_pk_fma_f32 v[64:65], v[58:59], v[48:49], v[64:65] op_sel:[0,1,0] op_sel_hi:[1,1,1]
    v_pk_fma_f32 v[18:19], v[62:63], v[48:49], v[18:19] op_sel:[0,1,0] op_sel_hi:[1,1,1]
    v_pk_fma_f32 v[64:65], v[60:61], v[50:51], v[64:65] op_sel:[0,0,0] op_sel_hi:[1,0,1]
    v_pk_fma_f32 v[22:23], v[62:63], v[50:51], v[22:23] op_sel:[0,0,0] op_sel_hi:[1,0,1]
    v_pk_mul_f32 v[66:67], v[56:57], v[106:107]
    v_pk_mul_f32 v[174:175], v[58:59], v[106:107]
    v_pk_mul_f32 v[176:177], v[60:61], v[106:107]
    v_pk_fma_f32 v[10:11], v[64:65], v[82:83], v[10:11]
    v_pk_fma_f32 v[26:27], v[56:57], v[98:99], v[26:27]
    v_pk_fma_f32 v[30:31], v[58:59], v[98:99], v[30:31]
    v_pk_fma_f32 v[34:35], v[60:61], v[98:99], v[34:35]
    v_pk_fma_f32 v[38:39], v[176:177], v[48:49], v[38:39] op_sel:[0,1,0] op_sel_hi:[1,1,1]
    v_pk_fma_f32 v[42:43], v[66:67], v[50:51], v[42:43] op_sel:[0,0,0] op_sel_hi:[1,0,1]
    v_pk_fma_f32 v[46:47], v[174:175], v[48:49], v[46:47] op_sel:[0,0,0] op_sel_hi:[1,0,1]
    v_pk_fma_f32 v[38:39], v[174:175], v[50:51], v[38:39] op_sel:[0,0,0] op_sel_hi:[1,0,1] neg_lo:[0,1,0] neg_hi:[0,1,0]
    v_pk_fma_f32 v[42:43], v[176:177], v[48:49], v[42:43] op_sel:[0,0,0] op_sel_hi:[1,0,1] neg_lo:[0,1,0] neg_hi:[0,1,0]
    v_pk_fma_f32 v[46:47], v[66:67], v[48:49], v[46:47] op_sel:[0,1,0] op_sel_hi:[1,1,1] neg_lo:[0,1,0] neg_hi:[0,1,0]
    s_sub_u32 s28, s28, 2
    s_cbranch_scc0 M_NOPOST_0
    s_call_b64 s[30:31], M_POST
M_NOPOST_0:
    ds_read_b64 v[148:149], v159 offset:128
    ds_read_b64 v[150:151], v159 offset:192
    ds_read_b32 v154, v160 offset:396
    ds_read_b32 v152, v159 offset:392
    ds_read_b32 v153, v159 offset:456
    s_waitcnt vmcnt(33)
    v_mfma_f32_16x16x32_bf16 v[68:71], v[144:147], a[0:3], 0
    v_mfma_f32_16x16x32_bf16 v[84:87], v[144:147], a[16:19], 0
    v_mfma_f32_16x16x32_bf16 v[76:79], v[144:147], a[8:11], 0
    v_mfma_f32_16x16x32_bf16 v[92:95], v[144:147], a[24:27], 0
    v_mfma_f32_16x16x32_bf16 v[100:103], v[144:147], a[32:35], 0
    v_mfma_f32_16x16x32_bf16 v[72:75], v[144:147], a[4:7], 0
    v_mfma_f32_16x16x32_bf16 v[88:91], v[144:147], a[20:23], 0
    v_mfma_f32_16x16x32_bf16 v[80:83], v[144:147], a[12:15], 0
    v_mfma_f32_16x16x32_bf16 v[96:99], v[144:147], a[28:31], 0
    v_mfma_f32_16x16x32_bf16 v[104:107], v[144:147], a[36:39], 0
    s_waitcnt lgkmcnt(0)
    v_add_u32 v158, v154, v162
    v_add_u32 v156, v152, v161
    v_add_u32 v157, v153, v161
    buffer_load_dwordx4 v[144:147], v158, s[12:15], 0 offen nt
    v_lshlrev_b32 v48, 16, v148
    v_and_b32 v49, v163, v148
    v_lshlrev_b32 v50, 16, v149
    s_waitcnt vmcnt(26)
    v_lshlrev_b32 v54, 16, v124
    v_and_b32 v55, v163, v124
    v_lshlrev_b32 v56, 16, v126
    v_and_b32 v57, v163, v126
    v_lshlrev_b32 v58, 16, v128
    v_and_b32 v59, v163, v128
    v_lshlrev_b32 v60, 16, v130
    v_and_b32 v61, v163, v130
    buffer_load_dword v124, v156, s[8:11], 0 offen offset:0
    buffer_load_dword v126, v156, s[8:11], 0 offen offset:128
    buffer_load_dword v128, v156, s[8:11], 0 offen offset:256
    buffer_load_dword v130, v156, s[8:11], 0 offen offset:384
    v_pk_fma_f32 v[4:5], v[54:55], v[68:69], v[4:5]
    v_pk_mul_f32 v[62:63], v[54:55], v[84:85]
    v_pk_mul_f32 v[64:65], v[56:57], v[48:49] op_sel:[0,0] op_sel_hi:[1,0]
    v_pk_fma_f32 v[12:13], v[62:63], v[48:49], v[12:13] op_sel:[0,0,0] op_sel_hi:[1,0,1]
    v_pk_fma_f32 v[64:65], v[58:59], v[48:49], v[64:65] op_sel:[0,1,0] op_sel_hi:[1,1,1]
    v_pk_fma_f32 v[16:17], v[62:63], v[48:49], v[16:17] op_sel:[0,1,0] op_sel_hi:[1,1,1]
    v_pk_fma_f32 v[64:65], v[60:61], v[50:51], v[64:65] op_sel:[0,0,0] op_sel_hi:[1,0,1]
    v_pk_fma_f32 v[20:21], v[62:63], v[50:51], v[20:21] op_sel:[0,0,0] op_sel_hi:[1,0,1]
    v_pk_mul_f32 v[66:67], v[56:57], v[100:101]
    v_pk_mul_f32 v[174:175], v[58:59], v[100:101]
    v_pk_mul_f32 v[176:177], v[60:61], v[100:101]
    v_pk_fma_f32 v[8:9], v[64:65], v[76:77], v[8:9]
    v_pk_fma_f32 v[24:25], v[56:57], v[92:93], v[24:25]
    v_pk_fma_f32 v[28:29], v[58:59], v[92:93], v[28:29]
    v_pk_fma_f32 v[32:33], v[60:61], v[92:93], v[32:33]
    v_pk_fma_f32 v[36:37], v[176:177], v[48:49], v[36:37] op_sel:[0,1,0] op_sel_hi:[1,1,1]
    v_pk_fma_f32 v[40:41], v[66:67], v[50:51], v[40:41] op_sel:[0,0,0] op_sel_hi:[1,0,1]
    v_pk_fma_f32 v[44:45], v[174:175], v[48:49], v[44:45] op_sel:[0,0,0] op_sel_hi:[1,0,1]
    v_pk_fma_f32 v[36:37], v[174:175], v[50:51], v[36:37] op_sel:[0,0,0] op_sel_hi:[1,0,1] neg_lo:[0,1,0] neg_hi:[0,1,0]
    v_pk_fma_f32 v[40:41], v[176:177], v[48:49], v[40:41] op_sel:[0,0,0] op_sel_hi:[1,0,1] neg_lo:[0,1,0] neg_hi:[0,1,0]
    v_pk_fma_f32 v[44:45], v[66:67], v[48:49], v[44:45] op_sel:[0,1,0] op_sel_hi:[1,1,1] neg_lo:[0,1,0] neg_hi:[0,1,0]
    v_lshlrev_b32 v54, 16, v125
    v_and_b32 v55, v163, v125
    v_lshlrev_b32 v56, 16, v127
    v_and_b32 v57, v163, v127
    v_lshlrev_b32 v58, 16, v129
    v_and_b32 v59, v163, v129
    v_lshlrev_b32 v60, 16, v131
    v_and_b32 v61, v163, v131
    buffer_load_dword v125, v156, s[8:11], 0 offen offset:64
    buffer_load_dword v127, v156, s[8:11], 0 offen offset:192
    buffer_load_dword v129, v156, s[8:11], 0 offen offset:320
    buffer_load_dword v131, v156, s[8:11], 0 offen offset:448
    v_pk_fma_f32 v[6:7], v[54:55], v[72:73], v[6:7]
    v_pk_mul_f32 v[62:63], v[54:55], v[88:89]
    v_pk_mul_f32 v[64:65], v[56:57], v[48:49] op_sel:[0,0] op_sel_hi:[1,0]
    v_pk_fma_f32 v[14:15], v[62:63], v[48:49], v[14:15] op_sel:[0,0,0] op_sel_hi:[1,0,1]
    v_pk_fma_f32 v[64:65], v[58:59], v[48:49], v[64:65] op_sel:[0,1,0] op_sel_hi:[1,1,1]
    v_pk_fma_f32 v[18:19], v[62:63], v[48:49], v[18:19] op_sel:[0,1,0] op_sel_hi:[1,1,1]
    v_pk_fma_f32 v[64:65], v[60:61], v[50:51], v[64:65] op_sel:[0,0,0] op_sel_hi:[1,0,1]
    v_pk_fma_f32 v[22:23], v[62:63], v[50:51], v[22:23] op_sel:[0,0,0] op_sel_hi:[1,0,1]
    v_pk_mul_f32 v[66:67], v[56:57], v[104:105]
    v_pk_mul_f32 v[174:175], v[58:59], v[104:105]
    v_pk_mul_f32 v[176:177], v[60:61], v[104:105]
    v_pk_fma_f32 v[10:11], v[64:65], v[80:81], v[10:11]
    v_pk_fma_f32 v[26:27], v[56:57], v[96:97], v[26:27]
    v_pk_fma_f32 v[30:31], v[58:59], v[96:97], v[30:31]
    v_pk_fma_f32 v[34:35], v[60:61], v[96:97], v[34:35]
    v_pk_fma_f32 v[38:39], v[176:177], v[48:49], v[38:39] op_sel:[0,1,0] op_sel_hi:[1,1,1]
    v_pk_fma_f32 v[42:43], v[66:67], v[50:51], v[42:43] op_sel:[0,0,0] op_sel_hi:[1,0,1]
    v_pk_fma_f32 v[46:47], v[174:175], v[48:49], v[46:47] op_sel:[0,0,0] op_sel_hi:[1,0,1]
    v_pk_fma_f32 v[38:39], v[174:175], v[50:51], v[38:39] op_sel:[0,0,0] op_sel_hi:[1,0,1] neg_lo:[0,1,0] neg_hi:[0,1,0]
    v_pk_fma_f32 v[42:43], v[176:177], v[48:49], v[42:43] op_sel:[0,0,0] op_sel_hi:[1,0,1] neg_lo:[0,1,0] neg_hi:[0,1,0]
    v_pk_fma_f32 v[46:47], v[66:67], v[48:49], v[46:47] op_sel:[0,1,0] op_sel_hi:[1,1,1] neg_lo:[0,1,0] neg_hi:[0,1,0]
    v_lshlrev_b32 v48, 16, v150
    v_and_b32 v49, v163, v150
    v_lshlrev_b32 v50, 16, v151
    s_waitcnt vmcnt(26)
    v_lshlrev_b32 v54, 16, v132
    v_and_b32 v55, v163, v132
    v_lshlrev_b32 v56, 16, v134
    v_and_b32 v57, v163, v134
    v_lshlrev_b32 v58, 16, v136
    v_and_b32 v59, v163, v136
    v_lshlrev_b32 v60, 16, v138
    v_and_b32 v61, v163, v138
    buffer_load_dword v132, v157, s[8:11], 0 offen offset:0
    buffer_load_dword v134, v157, s[8:11], 0 offen offset:128
    buffer_load_dword v136, v157, s[8:11], 0 offen offset:256
    buffer_load_dword v138, v157, s[8:11], 0 offen offset:384
    v_pk_fma_f32 v[4:5], v[54:55], v[70:71], v[4:5]
    v_pk_mul_f32 v[62:63], v[54:55], v[86:87]
    v_pk_mul_f32 v[64:65], v[56:57], v[48:49] op_sel:[0,0] op_sel_hi:[1,0]
    v_pk_fma_f32 v[12:13], v[62:63], v[48:49], v[12:13] op_sel:[0,0,0] op_sel_hi:[1,0,1]
    v_pk_fma_f32 v[64:65], v[58:59], v[48:49], v[64:65] op_sel:[0,1,0] op_sel_hi:[1,1,1]
    v_pk_fma_f32 v[16:17], v[62:63], v[48:49], v[16:17] op_sel:[0,1,0] op_sel_hi:[1,1,1]
    v_pk_fma_f32 v[64:65], v[60:61], v[50:51], v[64:65] op_sel:[0,0,0] op_sel_hi:[1,0,1]
    v_pk_fma_f32 v[20:21], v[62:63], v[50:51], v[20:21] op_sel:[0,0,0] op_sel_hi:[1,0,1]
    v_pk_mul_f32 v[66:67], v[56:57], v[102:103]
    v_pk_mul_f32 v[174:175], v[58:59], v[102:103]
    v_pk_mul_f32 v[176:177], v[60:61], v[102:103]
    v_pk_fma_f32 v[8:9], v[64:65], v[78:79], v[8:9]
    v_pk_fma_f32 v[24:25], v[56:57], v[94:95], v[24:25]
    v_pk_fma_f32 v[28:29], v[58:59], v[94:95], v[28:29]
    v_pk_fma_f32 v[32:33], v[60:61], v[94:95], v[32:33]
    v_pk_fma_f32 v[36:37], v[176:177], v[48:49], v[36:37] op_sel:[0,1,0] op_sel_hi:[1,1,1]
    v_pk_fma_f32 v[40:41], v[66:67], v[50:51], v[40:41] op_sel:[0,0,0] op_sel_hi:[1,0,1]
    v_pk_fma_f32 v[44:45], v[174:175], v[48:49], v[44:45] op_sel:[0,0,0] op_sel_hi:[1,0,1]
    v_pk_fma_f32 v[36:37], v[174:175], v[50:51], v[36:37] op_sel:[0,0,0] op_sel_hi:[1,0,1] neg_lo:[0,1,0] neg_hi:[0,1,0]
    v_pk_fma_f32 v[40:41], v[176:177], v[48:49], v[40:41] op_sel:[0,0,0] op_sel_hi:[1,0,1] neg_lo:[0,1,0] neg_hi:[0,1,0]
    v_pk_fma_f32 v[44:45], v[66:67], v[48:49], v[44:45] op_sel:[0,1,0] op_sel_hi:[1,1,1] neg_lo:[0,1,0] neg_hi:[0,1,0]
    v_lshlrev_b32 v54, 16, v133
    v_and_b32 v55, v163, v133
    v_lshlrev_b32 v56, 16, v135
    v_and_b32 v57, v163, v135
    v_lshlrev_b32 v58, 16, v137
    v_and_b32 v59, v163, v137
    v_lshlrev_b32 v60, 16, v139
    v_and_b32 v61, v163, v139
    buffer_load_dword v133, v157, s[8:11], 0 offen offset:64
    buffer_load_dword v135, v157, s[8:11], 0 offen offset:192
    buffer_load_dword v137, v157, s[8:11], 0 offen offset:320
    buffer_load_dword v139, v157, s[8:11], 0 offen offset:448
    v_pk_fma_f32 v[6:7], v[54:55], v[74:75], v[6:7]
    v_pk_mul_f32 v[62:63], v[54:55], v[90:91]
    v_pk_mul_f32 v[64:65], v[56:57], v[48:49] op_sel:[0,0] op_sel_hi:[1,0]
    v_pk_fma_f32 v[14:15], v[62:63], v[48:49], v[14:15] op_sel:[0,0,0] op_sel_hi:[1,0,1]
    v_pk_fma_f32 v[64:65], v[58:59], v[48:49], v[64:65] op_sel:[0,1,0] op_sel_hi:[1,1,1]
    v_pk_fma_f32 v[18:19], v[62:63], v[48:49], v[18:19] op_sel:[0,1,0] op_sel_hi:[1,1,1]
    v_pk_fma_f32 v[64:65], v[60:61], v[50:51], v[64:65] op_sel:[0,0,0] op_sel_hi:[1,0,1]
    v_pk_fma_f32 v[22:23], v[62:63], v[50:51], v[22:23] op_sel:[0,0,0] op_sel_hi:[1,0,1]
    v_pk_mul_f32 v[66:67], v[56:57], v[106:107]
    v_pk_mul_f32 v[174:175], v[58:59], v[106:107]
    v_pk_mul_f32 v[176:177], v[60:61], v[106:107]
    v_pk_fma_f32 v[10:11], v[64:65], v[82:83], v[10:11]
    v_pk_fma_f32 v[26:27], v[56:57], v[98:99], v[26:27]
    v_pk_fma_f32 v[30:31], v[58:59], v[98:99], v[30:31]
    v_pk_fma_f32 v[34:35], v[60:61], v[98:99], v[34:35]
    v_pk_fma_f32 v[38:39], v[176:177], v[48:49], v[38:39] op_sel:[0,1,0] op_sel_hi:[1,1,1]
    v_pk_fma_f32 v[42:43], v[66:67], v[50:51], v[42:43] op_sel:[0,0,0] op_sel_hi:[1,0,1]
    v_pk_fma_f32 v[46:47], v[174:175], v[48:49], v[46:47] op_sel:[0,0,0] op_sel_hi:[1,0,1]
    v_pk_fma_f32 v[38:39], v[174:175], v[50:51], v[38:39] op_sel:[0,0,0] op_sel_hi:[1,0,1] neg_lo:[0,1,0] neg_hi:[0,1,0]
    v_pk_fma_f32 v[42:43], v[176:177], v[48:49], v[42:43] op_sel:[0,0,0] op_sel_hi:[1,0,1] neg_lo:[0,1,0] neg_hi:[0,1,0]
    v_pk_fma_f32 v[46:47], v[66:67], v[48:49], v[46:47] op_sel:[0,1,0] op_sel_hi:[1,1,1] neg_lo:[0,1,0] neg_hi:[0,1,0]
    v_add_u32 v159, 256, v159
    v_add_u32 v160, 256, v160
    s_sub_u32 s28, s28, 2
    s_cbranch_scc0 M_LOOP
    s_call_b64 s[30:31], M_POST
    s_branch M_LOOP
M_POST:
    s_setprio 2
    v_cvt_pk_bf16_f32 v68, v4, v5
    v_cvt_pk_bf16_f32 v69, v6, v7
    ds_write_b64 v165, v[68:69] offset:0
    v_cvt_pk_bf16_f32 v70, v8, v9
    v_cvt_pk_bf16_f32 v71, v10, v11
    ds_write_b64 v165, v[70:71] offset:128
    v_cvt_pk_bf16_f32 v72, v12, v13
    v_cvt_pk_bf16_f32 v73, v14, v15
    ds_write_b64 v165, v[72:73] offset:256
    v_cvt_pk_bf16_f32 v74, v24, v25
    v_cvt_pk_bf16_f32 v75, v26, v27
    ds_write_b64 v165, v[74:75] offset:384
    v_cvt_pk_bf16_f32 v76, v36, v37
    v_cvt_pk_bf16_f32 v77, v38, v39
    ds_write_b64 v165, v[76:77] offset:512
    v_cvt_pk_bf16_f32 v78, v16, v17
    v_cvt_pk_bf16_f32 v79, v18, v19
    ds_write_b64 v165, v[78:79] offset:640
    v_cvt_pk_bf16_f32 v80, v28, v29
    v_cvt_pk_bf16_f32 v81, v30, v31
    ds_write_b64 v165, v[80:81] offset:768
    v_cvt_pk_bf16_f32 v82, v40, v41
    v_cvt_pk_bf16_f32 v83, v42, v43
    ds_write_b64 v165, v[82:83] offset:896
    v_cvt_pk_bf16_f32 v84, v20, v21
    v_cvt_pk_bf16_f32 v85, v22, v23
    ds_write_b64 v165, v[84:85] offset:1024
    v_cvt_pk_bf16_f32 v86, v32, v33
    v_cvt_pk_bf16_f32 v87, v34, v35
    ds_write_b64 v165, v[86:87] offset:1152
    v_cvt_pk_bf16_f32 v88, v44, v45
    v_cvt_pk_bf16_f32 v89, v46, v47
    ds_write_b64 v165, v[88:89] offset:1280
    v_readlane_b32 s37, v172, s29
    s_add_u32 s29, s29, 1
    s_waitcnt lgkmcnt(0)
    ds_read_b128 v[100:103], v166 offset:0
    ds_read_b128 v[4:7], v168 offset:0
    ds_read_b128 v[8:11], v168 offset:1024
    ds_read_b128 v[12:15], v168 offset:2048
    ds_read_b128 v[16:19], v168 offset:3072
    ds_read_b128 v[104:107], v166 offset:64
    ds_read_b128 v[20:23], v168 offset:4096
    ds_read_b128 v[24:27], v168 offset:5120
    ds_read_b128 v[28:31], v168 offset:6144
    ds_read_b128 v[32:35], v168 offset:7168
    v_bfe_u32 v61, s37, v170, 8
    v_add_u32 v62, s24, v61
    v_cmp_ne_u32 vcc, 0xff, v61
    v_lshl_add_u32 v62, v62, 9, v169
    s_nop 0
    v_cndmask_b32 v60, v164, v62, vcc
    s_waitcnt lgkmcnt(5)
    v_mfma_f32_16x16x32_bf16 v[68:71], v[4:7], v[100:103], 0
    v_mfma_f32_16x16x32_bf16 v[72:75], v[8:11], v[100:103], 0
    v_mfma_f32_16x16x32_bf16 v[76:79], v[12:15], v[100:103], 0
    v_mfma_f32_16x16x32_bf16 v[80:83], v[16:19], v[100:103], 0
    ds_read_b128 v[100:103], v166 offset:128
    ds_read_b128 v[4:7], v168 offset:8192
    ds_read_b128 v[8:11], v168 offset:9216
    ds_read_b128 v[12:15], v168 offset:10240
    ds_read_b128 v[16:19], v168 offset:11264
    s_waitcnt lgkmcnt(5)
    v_mfma_f32_16x16x32_bf16 v[68:71], v[20:23], v[104:107], v[68:71]
    v_mfma_f32_16x16x32_bf16 v[72:75], v[24:27], v[104:107], v[72:75]
    v_mfma_f32_16x16x32_bf16 v[76:79], v[28:31], v[104:107], v[76:79]
    v_mfma_f32_16x16x32_bf16 v[80:83], v[32:35], v[104:107], v[80:83]
    ds_read_b128 v[104:107], v166 offset:192
    ds_read_b128 v[20:23], v168 offset:12288
    ds_read_b128 v[24:27], v168 offset:13312
    ds_read_b128 v[28:31], v168 offset:14336
    ds_read_b128 v[32:35], v168 offset:15360
    s_waitcnt lgkmcnt(5)
    v_mfma_f32_16x16x32_bf16 v[68:71], v[4:7], v[100:103], v[68:71]
    v_mfma_f32_16x16x32_bf16 v[72:75], v[8:11], v[100:103], v[72:75]
    v_mfma_f32_16x16x32_bf16 v[76:79], v[12:15], v[100:103], v[76:79]
    v_mfma_f32_16x16x32_bf16 v[80:83], v[16:19], v[100:103], v[80:83]
    ds_read_b128 v[100:103], v167 offset:0
    ds_read_b128 v[4:7], v168 offset:16384
    ds_read_b128 v[8:11], v168 offset:17408
    ds_read_b128 v[12:15], v168 offset:18432
    ds_read_b128 v[16:19], v168 offset:19456
    s_waitcnt lgkmcnt(5)
    v_mfma_f32_16x16x32_bf16 v[68:71], v[20:23], v[104:107], v[68:71]
    v_mfma_f32_16x16x32_bf16 v[72:75], v[24:27], v[104:107], v[72:75]
    v_mfma_f32_16x16x32_bf16 v[76:79], v[28:31], v[104:107], v[76:79]
    v_mfma_f32_16x16x32_bf16 v[80:83], v[32:35], v[104:107], v[80:83]
    ds_read_b128 v[104:107], v167 offset:64
    ds_read_b128 v[20:23], v168 offset:20480
    ds_read_b128 v[24:27], v168 offset:21504
    ds_read_b128 v[28:31], v168 offset:22528
    ds_read_b128 v[32:35], v168 offset:23552
    s_waitcnt lgkmcnt(5)
    v_mfma_f32_16x16x32_bf16 v[84:87], v[4:7], v[100:103], 0
    v_mfma_f32_16x16x32_bf16 v[88:91], v[8:11], v[100:103], 0
    v_mfma_f32_16x16x32_bf16 v[92:95], v[12:15], v[100:103], 0
    v_mfma_f32_16x16x32_bf16 v[96:99], v[16:19], v[100:103], 0
    ds_read_b128 v[100:103], v167 offset:128
    ds_read_b128 v[4:7], v168 offset:24576
    ds_read_b128 v[8:11], v168 offset:25600
    ds_read_b128 v[12:15], v168 offset:26624
    ds_read_b128 v[16:19], v168 offset:27648
    s_waitcnt lgkmcnt(5)
    v_mfma_f32_16x16x32_bf16 v[84:87], v[20:23], v[104:107], v[84:87]
    v_mfma_f32_16x16x32_bf16 v[88:91], v[24:27], v[104:107], v[88:91]
    v_mfma_f32_16x16x32_bf16 v[92:95], v[28:31], v[104:107], v[92:95]
    v_mfma_f32_16x16x32_bf16 v[96:99], v[32:35], v[104:107], v[96:99]
    ds_read_b128 v[104:107], v167 offset:192
    ds_read_b128 v[20:23], v168 offset:28672
    ds_read_b128 v[24:27], v168 offset:29696
    ds_read_b128 v[28:31], v168 offset:30720
    ds_read_b128 v[32:35], v168 offset:31744
    s_waitcnt lgkmcnt(5)
    v_mfma_f32_16x16x32_bf16 v[84:87], v[4:7], v[100:103], v[84:87]
    v_mfma_f32_16x16x32_bf16 v[88:91], v[8:11], v[100:103], v[88:91]
    v_mfma_f32_16x16x32_bf16 v[92:95], v[12:15], v[100:103], v[92:95]
    v_mfma_f32_16x16x32_bf16 v[96:99], v[16:19], v[100:103], v[96:99]
    ds_read_b128 v[100:103], v167 offset:256
    ds_read_b128 v[4:7], v168 offset:32768
    ds_read_b128 v[8:11], v168 offset:33792
    ds_read_b128 v[12:15], v168 offset:34816
    ds_read_b128 v[16:19], v168 offset:35840
    v_pk_mov_b32 v[36:37], v[68:69], v[68:69] op_sel:[0,1]
    v_pk_mov_b32 v[38:39], v[70:71], v[70:71] op_sel:[0,1]
    s_mov_b64 exec, s[40:41]
    v_pk_mov_b32 v[36:37], v[72:73], v[72:73] op_sel:[0,1]
    v_pk_mov_b32 v[38:39], v[74:75], v[74:75] op_sel:[0,1]
    s_mov_b64 exec, s[42:43]
    v_pk_mov_b32 v[36:37], v[76:77], v[76:77] op_sel:[0,1]
    v_pk_mov_b32 v[38:39], v[78:79], v[78:79] op_sel:[0,1]
    s_mov_b64 exec, s[44:45]
    v_pk_mov_b32 v[36:37], v[80:81], v[80:81] op_sel:[0,1]
    v_pk_mov_b32 v[38:39], v[82:83], v[82:83] op_sel:[0,1]
    s_mov_b64 exec, -1
    v_mul_f32 v36, v173, v36
    v_mul_f32 v37, v173, v37
    v_mul_f32 v38, v173, v38
    v_mul_f32 v39, v173, v39
    v_exp_f32 v36, v36
    v_exp_f32 v37, v37
    v_exp_f32 v38, v38
    v_exp_f32 v39, v39
    s_waitcnt lgkmcnt(5)
    v_mfma_f32_16x16x32_bf16 v[84:87], v[20:23], v[104:107], v[84:87]
    v_mfma_f32_16x16x32_bf16 v[88:91], v[24:27], v[104:107], v[88:91]
    v_mfma_f32_16x16x32_bf16 v[92:95], v[28:31], v[104:107], v[92:95]
    v_mfma_f32_16x16x32_bf16 v[96:99], v[32:35], v[104:107], v[96:99]
    ds_read_b128 v[104:107], v167 offset:320
    ds_read_b128 v[20:23], v168 offset:36864
    ds_read_b128 v[24:27], v168 offset:37888
    ds_read_b128 v[28:31], v168 offset:38912
    ds_read_b128 v[32:35], v168 offset:39936
    v_add_f32 v36, 1.0, v36
    v_add_f32 v37, 1.0, v37
    v_add_f32 v38, 1.0, v38
    v_add_f32 v39, 1.0, v39
    v_rcp_f32 v36, v36
    v_rcp_f32 v37, v37
    v_rcp_f32 v38, v38
    v_rcp_f32 v39, v39
    s_waitcnt lgkmcnt(5)
    v_mfma_f32_16x16x32_bf16 v[84:87], v[4:7], v[100:103], v[84:87]
    v_mfma_f32_16x16x32_bf16 v[88:91], v[8:11], v[100:103], v[88:91]
    v_mfma_f32_16x16x32_bf16 v[92:95], v[12:15], v[100:103], v[92:95]
    v_mfma_f32_16x16x32_bf16 v[96:99], v[16:19], v[100:103], v[96:99]
    s_waitcnt lgkmcnt(0)
    v_mfma_f32_16x16x32_bf16 v[84:87], v[20:23], v[104:107], v[84:87]
    v_mfma_f32_16x16x32_bf16 v[88:91], v[24:27], v[104:107], v[88:91]
    v_mfma_f32_16x16x32_bf16 v[92:95], v[28:31], v[104:107], v[92:95]
    v_mfma_f32_16x16x32_bf16 v[96:99], v[32:35], v[104:107], v[96:99]
    s_nop 7
    v_mul_f32_dpp v40, v36, v84 quad_perm:[0,0,0,0] row_mask:0xf bank_mask:0xf
    v_mul_f32_dpp v41, v37, v85 quad_perm:[0,0,0,0] row_mask:0xf bank_mask:0xf
    v_mul_f32_dpp v42, v38, v86 quad_perm:[0,0,0,0] row_mask:0xf bank_mask:0xf
    v_mul_f32_dpp v43, v39, v87 quad_perm:[0,0,0,0] row_mask:0xf bank_mask:0xf
    v_mul_f32_dpp v44, v36, v88 quad_perm:[1,1,1,1] row_mask:0xf bank_mask:0xf
    v_mul_f32_dpp v45, v37, v89 quad_perm:[1,1,1,1] row_mask:0xf bank_mask:0xf
    v_mul_f32_dpp v46, v38, v90 quad_perm:[1,1,1,1] row_mask:0xf bank_mask:0xf
    v_mul_f32_dpp v47, v39, v91 quad_perm:[1,1,1,1] row_mask:0xf bank_mask:0xf
    v_mul_f32_dpp v48, v36, v92 quad_perm:[2,2,2,2] row_mask:0xf bank_mask:0xf
    v_mul_f32_dpp v49, v37, v93 quad_perm:[2,2,2,2] row_mask:0xf bank_mask:0xf
    v_mul_f32_dpp v50, v38, v94 quad_perm:[2,2,2,2] row_mask:0xf bank_mask:0xf
    v_mul_f32_dpp v51, v39, v95 quad_perm:[2,2,2,2] row_mask:0xf bank_mask:0xf
    v_mul_f32_dpp v52, v36, v96 quad_perm:[3,3,3,3] row_mask:0xf bank_mask:0xf
    v_mul_f32_dpp v53, v37, v97 quad_perm:[3,3,3,3] row_mask:0xf bank_mask:0xf
    v_mul_f32_dpp v54, v38, v98 quad_perm:[3,3,3,3] row_mask:0xf bank_mask:0xf
    v_mul_f32_dpp v55, v39, v99 quad_perm:[3,3,3,3] row_mask:0xf bank_mask:0xf
    s_mov_b64 exec, s[38:39]
    v_pk_mov_b32 v[40:41], v[68:69], v[68:69] op_sel:[0,1]
    v_pk_mov_b32 v[42:43], v[70:71], v[70:71] op_sel:[0,1]
    v_pk_mov_b32 v[44:45], v[72:73], v[72:73] op_sel:[0,1]
    v_pk_mov_b32 v[46:47], v[74:75], v[74:75] op_sel:[0,1]
    v_pk_mov_b32 v[48:49], v[76:77], v[76:77] op_sel:[0,1]
    v_pk_mov_b32 v[50:51], v[78:79], v[78:79] op_sel:[0,1]
    v_pk_mov_b32 v[52:53], v[80:81], v[80:81] op_sel:[0,1]
    v_pk_mov_b32 v[54:55], v[82:83], v[82:83] op_sel:[0,1]
    s_mov_b64 exec, -1
    v_cvt_pk_bf16_f32 v100, v40, v41
    v_cvt_pk_bf16_f32 v101, v42, v43
    v_cvt_pk_bf16_f32 v102, v44, v45
    v_cvt_pk_bf16_f32 v103, v46, v47
    v_cvt_pk_bf16_f32 v104, v48, v49
    v_cvt_pk_bf16_f32 v105, v50, v51
    v_cvt_pk_bf16_f32 v106, v52, v53
    v_cvt_pk_bf16_f32 v107, v54, v55
    buffer_store_dwordx4 v[100:103], v60, s[20:23], 0 offen sc0 sc1
    buffer_store_dwordx4 v[104:107], v60, s[20:23], 0 offen offset:64 sc0 sc1
    v_pk_mov_b32 v[4:5], 0, 0
    v_pk_mov_b32 v[6:7], 0, 0
    v_pk_mov_b32 v[8:9], 0, 0
    v_pk_mov_b32 v[10:11], 0, 0
    v_pk_mov_b32 v[12:13], 0, 0
    v_pk_mov_b32 v[14:15], 0, 0
    v_pk_mov_b32 v[16:17], 0, 0
    v_pk_mov_b32 v[18:19], 0, 0
    v_pk_mov_b32 v[20:21], 0, 0
    v_pk_mov_b32 v[22:23], 0, 0
    v_pk_mov_b32 v[24:25], 0, 0
    v_pk_mov_b32 v[26:27], 0, 0
    v_pk_mov_b32 v[28:29], 0, 0
    v_pk_mov_b32 v[30:31], 0, 0
    v_pk_mov_b32 v[32:33], 0, 0
    v_pk_mov_b32 v[34:35], 0, 0
    v_pk_mov_b32 v[36:37], 0, 0
    v_pk_mov_b32 v[38:39], 0, 0
    v_pk_mov_b32 v[40:41], 0, 0
    v_pk_mov_b32 v[42:43], 0, 0
    v_pk_mov_b32 v[44:45], 0, 0
    v_pk_mov_b32 v[46:47], 0, 0
M_POST_TAIL:
    s_setprio 0
    s_cmp_ge_u32 s29, s32
    s_cbranch_scc1 M_FIN
    v_readlane_b32 s28, v171, s29
    s_nop 0
    s_and_b32 s28, s28, 0x7fe
    s_sub_u32 s28, s28, 2
    s_cbranch_scc1 M_POST
    s_setpc_b64 s[30:31]
M_FIN:
    s_endpgm
M_SLOW:
    s_mov_b64 exec, -1
    s_waitcnt vmcnt(0) lgkmcnt(0)
    s_load_dwordx2 s[8:9], s[0:1], 0
    s_load_dwordx2 s[12:13], s[0:1], 24
    s_load_dwordx2 s[16:17], s[0:1], 32
    s_load_dwordx2 s[20:21], s[0:1], 8
    s_load_dwordx2 s[40:41], s[0:1], 16
    s_load_dwordx2 s[44:45], s[0:1], 40
    s_load_dwordx2 s[48:49], s[0:1], 48
    s_load_dwordx2 s[52:53], s[0:1], 56
    s_load_dwordx2 s[56:57], s[0:1], 72
    s_waitcnt lgkmcnt(0)
    s_mov_b32 s10, 25600000
    s_mov_b32 s11, 0x20000
    s_mov_b32 s14, 3200000
    s_mov_b32 s15, 0x20000
    s_mov_b32 s18, 3200000
    s_mov_b32 s19, 0x20000
    s_mov_b32 s22, 4800000
    s_mov_b32 s23, 0x20000
    s_mov_b32 s42, 25600000
    s_mov_b32 s43, 0x20000
    s_mov_b32 s46, 10240
    s_mov_b32 s47, 0x20000
    s_mov_b32 s50, 16384
    s_mov_b32 s51, 0x20000
    s_mov_b32 s54, 24576
    s_mov_b32 s55, 0x20000
    s_mov_b32 s58, 25600000
    s_mov_b32 s59, 0x20000
    v_lshlrev_b32 v150, 1, v1
    v_mov_b32 v151, 0
    v_lshlrev_b32 v152, 4, v1
    s_mov_b32 s63, 0
    buffer_load_ushort v8, v150, s[44:47], s63 offen
    s_mov_b32 s63, 640
    buffer_load_ushort v9, v150, s[44:47], s63 offen
    s_mov_b32 s63, 1280
    buffer_load_ushort v10, v150, s[44:47], s63 offen
    s_mov_b32 s63, 1920
    buffer_load_ushort v11, v150, s[44:47], s63 offen
    s_mov_b32 s63, 2560
    buffer_load_ushort v12, v150, s[44:47], s63 offen
    s_mov_b32 s63, 3200
    buffer_load_ushort v13, v150, s[44:47], s63 offen
    s_mov_b32 s63, 3840
    buffer_load_ushort v14, v150, s[44:47], s63 offen
    s_mov_b32 s63, 4480
    buffer_load_ushort v15, v150, s[44:47], s63 offen
    s_mov_b32 s63, 5120
    buffer_load_ushort v16, v150, s[44:47], s63 offen
    s_mov_b32 s63, 5760
    buffer_load_ushort v17, v150, s[44:47], s63 offen
    s_mov_b32 s63, 6400
    buffer_load_ushort v18, v150, s[44:47], s63 offen
    s_mov_b32 s63, 7040
    buffer_load_ushort v19, v150, s[44:47], s63 offen
    s_mov_b32 s63, 7680
    buffer_load_ushort v20, v150, s[44:47], s63 offen
    s_mov_b32 s63, 8320
    buffer_load_ushort v21, v150, s[44:47], s63 offen
    s_mov_b32 s63, 8960
    buffer_load_ushort v22, v150, s[44:47], s63 offen
    s_mov_b32 s63, 9600
    buffer_load_ushort v23, v150, s[44:47], s63 offen
    s_waitcnt vmcnt(0)
    s_mov_b32 s63, 128
    buffer_load_ushort v24, v150, s[44:47], s63 offen
    s_mov_b32 s63, 768
    buffer_load_ushort v25, v150, s[44:47], s63 offen
    s_mov_b32 s63, 1408
    buffer_load_ushort v26, v150, s[44:47], s63 offen
    s_mov_b32 s63, 2048
    buffer_load_ushort v27, v150, s[44:47], s63 offen
    s_mov_b32 s63, 2688
    buffer_load_ushort v28, v150, s[44:47], s63 offen
    s_mov_b32 s63, 3328
    buffer_load_ushort v29, v150, s[44:47], s63 offen
    s_mov_b32 s63, 3968
    buffer_load_ushort v30, v150, s[44:47], s63 offen
    s_mov_b32 s63, 4608
    buffer_load_ushort v31, v150, s[44:47], s63 offen
    s_mov_b32 s63, 5248
    buffer_load_ushort v32, v150, s[44:47], s63 offen
    s_mov_b32 s63, 5888
    buffer_load_ushort v33, v150, s[44:47], s63 offen
    s_mov_b32 s63, 6528
    buffer_load_ushort v34, v150, s[44:47], s63 offen
    s_mov_b32 s63, 7168
    buffer_load_ushort v35, v150, s[44:47], s63 offen
    s_mov_b32 s63, 7808
    buffer_load_ushort v36, v150, s[44:47], s63 offen
    s_mov_b32 s63, 8448
    buffer_load_ushort v37, v150, s[44:47], s63 offen
    s_mov_b32 s63, 9088
    buffer_load_ushort v38, v150, s[44:47], s63 offen
    s_mov_b32 s63, 9728
    buffer_load_ushort v39, v150, s[44:47], s63 offen
    s_waitcnt vmcnt(0)
    s_mov_b32 s63, 256
    buffer_load_ushort v40, v150, s[44:47], s63 offen
    s_mov_b32 s63, 896
    buffer_load_ushort v41, v150, s[44:47], s63 offen
    s_mov_b32 s63, 1536
    buffer_load_ushort v42, v150, s[44:47], s63 offen
    s_mov_b32 s63, 2176
    buffer_load_ushort v43, v150, s[44:47], s63 offen
    s_mov_b32 s63, 2816
    buffer_load_ushort v44, v150, s[44:47], s63 offen
    s_mov_b32 s63, 3456
    buffer_load_ushort v45, v150, s[44:47], s63 offen
    s_mov_b32 s63, 4096
    buffer_load_ushort v46, v150, s[44:47], s63 offen
    s_mov_b32 s63, 4736
    buffer_load_ushort v47, v150, s[44:47], s63 offen
    s_mov_b32 s63, 5376
    buffer_load_ushort v48, v150, s[44:47], s63 offen
    s_mov_b32 s63, 6016
    buffer_load_ushort v49, v150, s[44:47], s63 offen
    s_mov_b32 s63, 6656
    buffer_load_ushort v50, v150, s[44:47], s63 offen
    s_mov_b32 s63, 7296
    buffer_load_ushort v51, v150, s[44:47], s63 offen
    s_mov_b32 s63, 7936
    buffer_load_ushort v52, v150, s[44:47], s63 offen
    s_mov_b32 s63, 8576
    buffer_load_ushort v53, v150, s[44:47], s63 offen
    s_mov_b32 s63, 9216
    buffer_load_ushort v54, v150, s[44:47], s63 offen
    s_mov_b32 s63, 9856
    buffer_load_ushort v55, v150, s[44:47], s63 offen
    s_waitcnt vmcnt(0)
    s_mov_b32 s63, 384
    buffer_load_ushort v56, v150, s[44:47], s63 offen
    s_mov_b32 s63, 1024
    buffer_load_ushort v57, v150, s[44:47], s63 offen
    s_mov_b32 s63, 1664
    buffer_load_ushort v58, v150, s[44:47], s63 offen
    s_mov_b32 s63, 2304
    buffer_load_ushort v59, v150, s[44:47], s63 offen
    s_mov_b32 s63, 2944
    buffer_load_ushort v60, v150, s[44:47], s63 offen
    s_mov_b32 s63, 3584
    buffer_load_ushort v61, v150, s[44:47], s63 offen
    s_mov_b32 s63, 4224
    buffer_load_ushort v62, v150, s[44:47], s63 offen
    s_mov_b32 s63, 4864
    buffer_load_ushort v63, v150, s[44:47], s63 offen
    s_mov_b32 s63, 5504
    buffer_load_ushort v64, v150, s[44:47], s63 offen
    s_mov_b32 s63, 6144
    buffer_load_ushort v65, v150, s[44:47], s63 offen
    s_mov_b32 s63, 6784
    buffer_load_ushort v66, v150, s[44:47], s63 offen
    s_mov_b32 s63, 7424
    buffer_load_ushort v67, v150, s[44:47], s63 offen
    s_mov_b32 s63, 8064
    buffer_load_ushort v68, v150, s[44:47], s63 offen
    s_mov_b32 s63, 8704
    buffer_load_ushort v69, v150, s[44:47], s63 offen
    s_mov_b32 s63, 9344
    buffer_load_ushort v70, v150, s[44:47], s63 offen
    s_mov_b32 s63, 9984
    buffer_load_ushort v71, v150, s[44:47], s63 offen
    s_waitcnt vmcnt(0)
    s_mov_b32 s63, 512
    buffer_load_ushort v72, v150, s[44:47], s63 offen
    s_mov_b32 s63, 1152
    buffer_load_ushort v73, v150, s[44:47], s63 offen
    s_mov_b32 s63, 1792
    buffer_load_ushort v74, v150, s[44:47], s63 offen
    s_mov_b32 s63, 2432
    buffer_load_ushort v75, v150, s[44:47], s63 offen
    s_mov_b32 s63, 3072
    buffer_load_ushort v76, v150, s[44:47], s63 offen
    s_mov_b32 s63, 3712
    buffer_load_ushort v77, v150, s[44:47], s63 offen
    s_mov_b32 s63, 4352
    buffer_load_ushort v78, v150, s[44:47], s63 offen
    s_mov_b32 s63, 4992
    buffer_load_ushort v79, v150, s[44:47], s63 offen
    s_mov_b32 s63, 5632
    buffer_load_ushort v80, v150, s[44:47], s63 offen
    s_mov_b32 s63, 6272
    buffer_load_ushort v81, v150, s[44:47], s63 offen
    s_mov_b32 s63, 6912
    buffer_load_ushort v82, v150, s[44:47], s63 offen
    s_mov_b32 s63, 7552
    buffer_load_ushort v83, v150, s[44:47], s63 offen
    s_mov_b32 s63, 8192
    buffer_load_ushort v84, v150, s[44:47], s63 offen
    s_mov_b32 s63, 8832
    buffer_load_ushort v85, v150, s[44:47], s63 offen
    s_mov_b32 s63, 9472
    buffer_load_ushort v86, v150, s[44:47], s63 offen
    s_mov_b32 s63, 10112
    buffer_load_ushort v87, v150, s[44:47], s63 offen
    s_waitcnt vmcnt(0)
    v_lshlrev_b32 v8, 16, v8
    v_lshlrev_b32 v9, 16, v9
    v_lshlrev_b32 v10, 16, v10
    v_lshlrev_b32 v11, 16, v11
    v_lshlrev_b32 v12, 16, v12
    v_lshlrev_b32 v13, 16, v13
    v_lshlrev_b32 v14, 16, v14
    v_lshlrev_b32 v15, 16, v15
    v_lshlrev_b32 v16, 16, v16
    v_lshlrev_b32 v17, 16, v17
    v_lshlrev_b32 v18, 16, v18
    v_lshlrev_b32 v19, 16, v19
    v_lshlrev_b32 v20, 16, v20
    v_lshlrev_b32 v21, 16, v21
    v_lshlrev_b32 v22, 16, v22
    v_lshlrev_b32 v23, 16, v23
    v_lshlrev_b32 v24, 16, v24
    v_lshlrev_b32 v25, 16, v25
    v_lshlrev_b32 v26, 16, v26
    v_lshlrev_b32 v27, 16, v27
    v_lshlrev_b32 v28, 16, v28
    v_lshlrev_b32 v29, 16, v29
    v_lshlrev_b32 v30, 16, v30
    v_lshlrev_b32 v31, 16, v31
    v_lshlrev_b32 v32, 16, v32
    v_lshlrev_b32 v33, 16, v33
    v_lshlrev_b32 v34, 16, v34
    v_lshlrev_b32 v35, 16, v35
    v_lshlrev_b32 v36, 16, v36
    v_lshlrev_b32 v37, 16, v37
    v_lshlrev_b32 v38, 16, v38
    v_lshlrev_b32 v39, 16, v39
    v_lshlrev_b32 v40, 16, v40
    v_lshlrev_b32 v41, 16, v41
    v_lshlrev_b32 v42, 16, v42
    v_lshlrev_b32 v43, 16, v43
    v_lshlrev_b32 v44, 16, v44
    v_lshlrev_b32 v45, 16, v45
    v_lshlrev_b32 v46, 16, v46
    v_lshlrev_b32 v47, 16, v47
    v_lshlrev_b32 v48, 16, v48
    v_lshlrev_b32 v49, 16, v49
    v_lshlrev_b32 v50, 16, v50
    v_lshlrev_b32 v51, 16, v51
    v_lshlrev_b32 v52, 16, v52
    v_lshlrev_b32 v53, 16, v53
    v_lshlrev_b32 v54, 16, v54
    v_lshlrev_b32 v55, 16, v55
    v_lshlrev_b32 v56, 16, v56
    v_lshlrev_b32 v57, 16, v57
    v_lshlrev_b32 v58, 16, v58
    v_lshlrev_b32 v59, 16, v59
    v_lshlrev_b32 v60, 16, v60
    v_lshlrev_b32 v61, 16, v61
    v_lshlrev_b32 v62, 16, v62
    v_lshlrev_b32 v63, 16, v63
    v_lshlrev_b32 v64, 16, v64
    v_lshlrev_b32 v65, 16, v65
    v_lshlrev_b32 v66, 16, v66
    v_lshlrev_b32 v67, 16, v67
    v_lshlrev_b32 v68, 16, v68
    v_lshlrev_b32 v69, 16, v69
    v_lshlrev_b32 v70, 16, v70
    v_lshlrev_b32 v71, 16, v71
    v_lshlrev_b32 v72, 16, v72
    v_lshlrev_b32 v73, 16, v73
    v_lshlrev_b32 v74, 16, v74
    v_lshlrev_b32 v75, 16, v75
    v_lshlrev_b32 v76, 16, v76
    v_lshlrev_b32 v77, 16, v77
    v_lshlrev_b32 v78, 16, v78
    v_lshlrev_b32 v79, 16, v79
    v_lshlrev_b32 v80, 16, v80
    v_lshlrev_b32 v81, 16, v81
    v_lshlrev_b32 v82, 16, v82
    v_lshlrev_b32 v83, 16, v83
    v_lshlrev_b32 v84, 16, v84
    v_lshlrev_b32 v85, 16, v85
    v_lshlrev_b32 v86, 16, v86
    v_lshlrev_b32 v87, 16, v87
    s_mov_b32 s61, s26
S_NODE:
    s_cmp_ge_u32 s61, s25
    s_cbranch_scc1 S_END
    s_add_u32 s60, s24, s61
    v_mov_b32 v88, 0
    v_mov_b32 v89, 0
    v_mov_b32 v90, 0
    v_mov_b32 v91, 0
    v_mov_b32 v92, 0
    v_mov_b32 v93, 0
    v_mov_b32 v94, 0
    v_mov_b32 v95, 0
    v_mov_b32 v96, 0
    v_mov_b32 v97, 0
    v_mov_b32 v98, 0
    s_mov_b32 s62, 0
S_BLK:
    s_lshl_b32 s63, s62, 2
    buffer_load_dwordx4 v[136:139], v152, s[16:19], s63 offen
    s_waitcnt vmcnt(0)
    v_cmp_eq_u32 s[70:71], s60, v136
    v_cmp_eq_u32 s[72:73], s60, v137
    v_cmp_eq_u32 s[74:75], s60, v138
    v_cmp_eq_u32 s[76:77], s60, v139
    s_mov_b64 s[68:69], s[70:71]
S_BITS0:
    s_cmp_eq_u64 s[68:69], 0
    s_cbranch_scc1 S_BITS0_DONE
    s_ff1_i32_b64 s66, s[68:69]
    s_bitset0_b64 s[68:69], s66
    s_lshl_b32 s64, s66, 2
    s_add_u32 s64, s64, s62
    s_add_u32 s64, s64, 0
    s_call_b64 s[30:31], S_EDGE
    s_branch S_BITS0
S_BITS0_DONE:
    s_mov_b64 s[68:69], s[72:73]
S_BITS1:
    s_cmp_eq_u64 s[68:69], 0
    s_cbranch_scc1 S_BITS1_DONE
    s_ff1_i32_b64 s66, s[68:69]
    s_bitset0_b64 s[68:69], s66
    s_lshl_b32 s64, s66, 2
    s_add_u32 s64, s64, s62
    s_add_u32 s64, s64, 1
    s_call_b64 s[30:31], S_EDGE
    s_branch S_BITS1
S_BITS1_DONE:
    s_mov_b64 s[68:69], s[74:75]
S_BITS2:
    s_cmp_eq_u64 s[68:69], 0
    s_cbranch_scc1 S_BITS2_DONE
    s_ff1_i32_b64 s66, s[68:69]
    s_bitset0_b64 s[68:69], s66
    s_lshl_b32 s64, s66, 2
    s_add_u32 s64, s64, s62
    s_add_u32 s64, s64, 2
    s_call_b64 s[30:31], S_EDGE
    s_branch S_BITS2
S_BITS2_DONE:
    s_mov_b64 s[68:69], s[76:77]
S_BITS3:
    s_cmp_eq_u64 s[68:69], 0
    s_cbranch_scc1 S_BITS3_DONE
    s_ff1_i32_b64 s66, s[68:69]
    s_bitset0_b64 s[68:69], s66
    s_lshl_b32 s64, s66, 2
    s_add_u32 s64, s64, s62
    s_add_u32 s64, s64, 3
    s_call_b64 s[30:31], S_EDGE
    s_branch S_BITS3
S_BITS3_DONE:
    s_add_u32 s62, s62, 256
    s_cmp_lt_u32 s62, 800000
    s_cbranch_scc1 S_BLK
    v_mov_b32 v140, 0
    v_mov_b32 v141, 0
    v_mov_b32 v142, 0
    v_mov_b32 v143, 0
    s_mov_b32 s65, 0
S_POST:
    s_lshl_b32 s63, s65, 7
    buffer_load_ushort v144, v150, s[48:51], s63 offen
    buffer_load_ushort v146, v150, s[52:55], s63 offen
    s_add_u32 s63, s63, 8192
    buffer_load_ushort v145, v150, s[48:51], s63 offen
    buffer_load_ushort v147, v150, s[52:55], s63 offen
    s_add_u32 s63, s63, 8192
    buffer_load_ushort v148, v150, s[52:55], s63 offen
    v_readlane_b32 s80, v88, s65
    v_readlane_b32 s81, v89, s65
    v_readlane_b32 s82, v90, s65
    v_readlane_b32 s83, v91, s65
    v_readlane_b32 s84, v92, s65
    v_readlane_b32 s85, v93, s65
    v_readlane_b32 s86, v94, s65
    v_readlane_b32 s87, v95, s65
    v_readlane_b32 s88, v96, s65
    v_readlane_b32 s89, v97, s65
    v_readlane_b32 s90, v98, s65
    s_waitcnt vmcnt(0)
    v_lshlrev_b32 v144, 16, v144
    v_lshlrev_b32 v145, 16, v145
    v_lshlrev_b32 v146, 16, v146
    v_lshlrev_b32 v147, 16, v147
    v_lshlrev_b32 v148, 16, v148
    v_fmac_f32 v140, s80, v144
    v_fmac_f32 v140, s81, v145
    v_fmac_f32 v141, s82, v146
    v_fmac_f32 v141, s85, v147
    v_fmac_f32 v141, s88, v148
    v_fmac_f32 v142, s83, v146
    v_fmac_f32 v142, s86, v147
    v_fmac_f32 v142, s89, v148
    v_fmac_f32 v143, s84, v146
    v_fmac_f32 v143, s87, v147
    v_fmac_f32 v143, s90, v148
    s_add_u32 s65, s65, 1
    s_cmp_lt_u32 s65, 64
    s_cbranch_scc1 S_POST
    v_mul_f32 v130, 0xbfb8aa3b, v140
    v_exp_f32 v130, v130
    s_nop 0
    v_add_f32 v130, 1.0, v130
    v_rcp_f32 v130, v130
    s_nop 0
    v_mul_f32 v141, v141, v130
    v_mul_f32 v142, v142, v130
    v_mul_f32 v143, v143, v130
    s_lshl_b32 s63, s60, 9
    v_cvt_pk_bf16_f32 v131, v140, v140
    v_cvt_pk_bf16_f32 v132, v141, v141
    v_cvt_pk_bf16_f32 v133, v142, v142
    v_cvt_pk_bf16_f32 v134, v143, v143
    buffer_store_short v131, v150, s[56:59], s63 offen offset:0
    buffer_store_short v132, v150, s[56:59], s63 offen offset:128
    buffer_store_short v133, v150, s[56:59], s63 offen offset:256
    buffer_store_short v134, v150, s[56:59], s63 offen offset:384
    s_add_u32 s61, s61, 8
    s_branch S_NODE
S_EDGE:
    s_lshl_b32 s63, s64, 2
    buffer_load_dword v153, v151, s[12:15], s63 offen
    s_mul_i32 s63, s64, 6
    buffer_load_ushort v116, v151, s[20:23], s63 offen offset:0
    buffer_load_ushort v117, v151, s[20:23], s63 offen offset:2
    buffer_load_ushort v118, v151, s[20:23], s63 offen offset:4
    s_lshl_b32 s63, s64, 5
    buffer_load_ushort v100, v151, s[40:43], s63 offen offset:0
    buffer_load_ushort v101, v151, s[40:43], s63 offen offset:2
    buffer_load_ushort v102, v151, s[40:43], s63 offen offset:4
    buffer_load_ushort v103, v151, s[40:43], s63 offen offset:6
    buffer_load_ushort v104, v151, s[40:43], s63 offen offset:8
    buffer_load_ushort v105, v151, s[40:43], s63 offen offset:10
    buffer_load_ushort v106, v151, s[40:43], s63 offen offset:12
    buffer_load_ushort v107, v151, s[40:43], s63 offen offset:14
    buffer_load_ushort v108, v151, s[40:43], s63 offen offset:16
    buffer_load_ushort v109, v151, s[40:43], s63 offen offset:18
    buffer_load_ushort v110, v151, s[40:43], s63 offen offset:20
    buffer_load_ushort v111, v151, s[40:43], s63 offen offset:22
    buffer_load_ushort v112, v151, s[40:43], s63 offen offset:24
    buffer_load_ushort v113, v151, s[40:43], s63 offen offset:26
    buffer_load_ushort v114, v151, s[40:43], s63 offen offset:28
    buffer_load_ushort v115, v151, s[40:43], s63 offen offset:30
    s_waitcnt vmcnt(19)
    v_lshl_add_u32 v153, v153, 9, v150
    buffer_load_ushort v120, v153, s[8:11], 0 offen offset:0
    buffer_load_ushort v121, v153, s[8:11], 0 offen offset:128
    buffer_load_ushort v122, v153, s[8:11], 0 offen offset:256
    buffer_load_ushort v123, v153, s[8:11], 0 offen offset:384
    s_waitcnt vmcnt(0)
    v_lshlrev_b32 v116, 16, v116
    v_lshlrev_b32 v117, 16, v117
    v_lshlrev_b32 v118, 16, v118
    v_lshlrev_b32 v100, 16, v100
    v_lshlrev_b32 v101, 16, v101
    v_lshlrev_b32 v102, 16, v102
    v_lshlrev_b32 v103, 16, v103
    v_lshlrev_b32 v104, 16, v104
    v_lshlrev_b32 v105, 16, v105
    v_lshlrev_b32 v106, 16, v106
    v_lshlrev_b32 v107, 16, v107
    v_lshlrev_b32 v108, 16, v108
    v_lshlrev_b32 v109, 16, v109
    v_lshlrev_b32 v110, 16, v110
    v_lshlrev_b32 v111, 16, v111
    v_lshlrev_b32 v112, 16, v112
    v_lshlrev_b32 v113, 16, v113
    v_lshlrev_b32 v114, 16, v114
    v_lshlrev_b32 v115, 16, v115
    v_lshlrev_b32 v120, 16, v120
    v_lshlrev_b32 v121, 16, v121
    v_lshlrev_b32 v122, 16, v122
    v_lshlrev_b32 v123, 16, v123
    v_mul_f32 v124, v100, v8
    v_fmac_f32 v124, v101, v9
    v_fmac_f32 v124, v102, v10
    v_fmac_f32 v124, v103, v11
    v_fmac_f32 v124, v104, v12
    v_fmac_f32 v124, v105, v13
    v_fmac_f32 v124, v106, v14
    v_fmac_f32 v124, v107, v15
    v_fmac_f32 v124, v108, v16
    v_fmac_f32 v124, v109, v17
    v_fmac_f32 v124, v110, v18
    v_fmac_f32 v124, v111, v19
    v_fmac_f32 v124, v112, v20
    v_fmac_f32 v124, v113, v21
    v_fmac_f32 v124, v114, v22
    v_fmac_f32 v124, v115, v23
    v_mul_f32 v125, v100, v24
    v_fmac_f32 v125, v101, v25
    v_fmac_f32 v125, v102, v26
    v_fmac_f32 v125, v103, v27
    v_fmac_f32 v125, v104, v28
    v_fmac_f32 v125, v105, v29
    v_fmac_f32 v125, v106, v30
    v_fmac_f32 v125, v107, v31
    v_fmac_f32 v125, v108, v32
    v_fmac_f32 v125, v109, v33
    v_fmac_f32 v125, v110, v34
    v_fmac_f32 v125, v111, v35
    v_fmac_f32 v125, v112, v36
    v_fmac_f32 v125, v113, v37
    v_fmac_f32 v125, v114, v38
    v_fmac_f32 v125, v115, v39
    v_mul_f32 v126, v100, v40
    v_fmac_f32 v126, v101, v41
    v_fmac_f32 v126, v102, v42
    v_fmac_f32 v126, v103, v43
    v_fmac_f32 v126, v104, v44
    v_fmac_f32 v126, v105, v45
    v_fmac_f32 v126, v106, v46
    v_fmac_f32 v126, v107, v47
    v_fmac_f32 v126, v108, v48
    v_fmac_f32 v126, v109, v49
    v_fmac_f32 v126, v110, v50
    v_fmac_f32 v126, v111, v51
    v_fmac_f32 v126, v112, v52
    v_fmac_f32 v126, v113, v53
    v_fmac_f32 v126, v114, v54
    v_fmac_f32 v126, v115, v55
    v_mul_f32 v127, v100, v56
    v_fmac_f32 v127, v101, v57
    v_fmac_f32 v127, v102, v58
    v_fmac_f32 v127, v103, v59
    v_fmac_f32 v127, v104, v60
    v_fmac_f32 v127, v105, v61
    v_fmac_f32 v127, v106, v62
    v_fmac_f32 v127, v107, v63
    v_fmac_f32 v127, v108, v64
    v_fmac_f32 v127, v109, v65
    v_fmac_f32 v127, v110, v66
    v_fmac_f32 v127, v111, v67
    v_fmac_f32 v127, v112, v68
    v_fmac_f32 v127, v113, v69
    v_fmac_f32 v127, v114, v70
    v_fmac_f32 v127, v115, v71
    v_mul_f32 v128, v100, v72
    v_fmac_f32 v128, v101, v73
    v_fmac_f32 v128, v102, v74
    v_fmac_f32 v128, v103, v75
    v_fmac_f32 v128, v104, v76
    v_fmac_f32 v128, v105, v77
    v_fmac_f32 v128, v106, v78
    v_fmac_f32 v128, v107, v79
    v_fmac_f32 v128, v108, v80
    v_fmac_f32 v128, v109, v81
    v_fmac_f32 v128, v110, v82
    v_fmac_f32 v128, v111, v83
    v_fmac_f32 v128, v112, v84
    v_fmac_f32 v128, v113, v85
    v_fmac_f32 v128, v114, v86
    v_fmac_f32 v128, v115, v87
    v_fmac_f32 v88, v120, v124
    v_mul_f32 v130, v120, v126
    v_fmac_f32 v90, v130, v116
    v_fmac_f32 v91, v130, v117
    v_fmac_f32 v92, v130, v118
    v_mul_f32 v130, v121, v116
    v_fmac_f32 v130, v122, v117
    v_fmac_f32 v130, v123, v118
    v_fmac_f32 v89, v130, v125
    v_fmac_f32 v93, v121, v127
    v_fmac_f32 v94, v122, v127
    v_fmac_f32 v95, v123, v127
    v_mul_f32 v131, v121, v128
    v_mul_f32 v132, v122, v128
    v_mul_f32 v133, v123, v128
    v_fmac_f32 v96, v117, v133
    v_fma_f32 v96, -v118, v132, v96
    v_fmac_f32 v97, v118, v131
    v_fma_f32 v97, -v116, v133, v97
    v_fmac_f32 v98, v116, v132
    v_fma_f32 v98, -v117, v131, v98
    s_setpc_b64 s[30:31]
S_END:
    s_endpgm
M_END:
    s_endpgm
.section .rodata,"a"
.p2align 6
.amdhsa_kernel prep_kernel
  .amdhsa_next_free_vgpr 64
  .amdhsa_next_free_sgpr 64
  .amdhsa_accum_offset 64
  .amdhsa_group_segment_fixed_size 0
  .amdhsa_kernarg_size 96
  .amdhsa_user_sgpr_count 2
  .amdhsa_user_sgpr_kernarg_segment_ptr 1
  .amdhsa_system_sgpr_workgroup_id_x 1
  .amdhsa_float_denorm_mode_32 3
.end_amdhsa_kernel
.p2align 6
.amdhsa_kernel main_kernel
  .amdhsa_next_free_vgpr 220
  .amdhsa_next_free_sgpr 96
  .amdhsa_accum_offset 180
  .amdhsa_group_segment_fixed_size 0
  .amdhsa_kernarg_size 96
  .amdhsa_user_sgpr_count 2
  .amdhsa_user_sgpr_kernarg_segment_ptr 1
  .amdhsa_system_sgpr_workgroup_id_x 1
  .amdhsa_float_denorm_mode_32 3
.end_amdhsa_kernel
```
